```python
import torch

def _softmax(x, axis=-1):
    return torch.softmax(x, dim=axis)
def _gelu(x):
    return torch.nn.functional.gelu(x, approximate="tanh")
def _silu(x):
    return torch.nn.functional.silu(x)
def _sigmoid(x):
    return torch.sigmoid(x)
def _layernorm(x, axis=-1, eps=1e-5):
    m = x.mean(dim=axis, keepdim=True)
    v = x.var(dim=axis, keepdim=True, unbiased=False)
    return (x - m) / torch.sqrt(v + eps)
def _scatter_add(tgt, idx, src, axis=0):
    return tgt.clone().index_add_(axis, idx, src)
def _segment_sum(src, seg, n):
    out = torch.zeros((n,) + src.shape[1:], dtype=src.dtype)
    return out.index_add_(0, seg, src)
def _pad(x, pw):
    flat = tuple(v for pair in reversed(pw) for v in pair)
    return torch.nn.functional.pad(x, flat)

kernel_name = 'sequential_preLN__softmax_full_mha__geglu_ffn__prompt'

def setup_inputs():

    _w = (lambda a: (lambda t: t.to(torch.bfloat16) if t.is_floating_point() else t)(torch.as_tensor(a)))
    def _A_setup():
        B, S, D = 1, 2048, 512
        return {
            "x": _w((lambda *s: torch.randn(*s, dtype=torch.bfloat16) * 0.05)(B, S, D)),
            "wqkv": _w((lambda *s: torch.randn(*s, dtype=torch.bfloat16) * 0.05)(D, 3 * D)),
            "wo": _w((lambda *s: torch.randn(*s, dtype=torch.bfloat16) * 0.05)(D, D)),
        }
    _A_in = _A_setup()

    def _B_setup():
        B, S, D, F = 1, 2048, 512, 1792
        return {
            "x": _w((lambda *s: torch.randn(*s, dtype=torch.bfloat16) * 0.05)(B, S, D)),
            "w_gate": _w((lambda *s: torch.randn(*s, dtype=torch.bfloat16) * 0.05)(D, F)),
            "w_up": _w((lambda *s: torch.randn(*s, dtype=torch.bfloat16) * 0.05)(D, F)),
            "w_down": _w((lambda *s: torch.randn(*s, dtype=torch.bfloat16) * 0.05)(F, D)),
        }
    _B_in = _B_setup()

    return {
        "A_x": _A_in["x"],
        "A_wqkv": _A_in["wqkv"],
        "A_wo": _A_in["wo"],
        "B_x": _B_in["x"],
        "B_w_gate": _B_in["w_gate"],
        "B_w_up": _B_in["w_up"],
        "B_w_down": _B_in["w_down"],
    }

def reference(A_x, A_wqkv, A_wo, B_x, B_w_gate, B_w_up, B_w_down):
    def _A_ref(x, wqkv, wo):
        B, S, D = x.shape
        H = 32; Dh = D // H
        qkv = (lambda x, *d: x.permute(*d))((x @ wqkv).reshape(B, S, 3, H, Dh), 2, 0, 3, 1, 4)
        q, k, v = qkv[0], qkv[1], qkv[2]
        scale = Dh ** -0.5
        scores = torch.einsum("bhqd,bhkd->bhqk", q, k) * scale
        p = _softmax(scores, axis=-1)
        o = torch.einsum("bhqk,bhkd->bhqd", p, v)
        return (lambda x, *d: x.permute(*d))(o, 0, 2, 1, 3).reshape(B, S, D) @ wo

    def _B_ref(x, w_gate, w_up, w_down):
        return (_gelu(x @ w_gate) * (x @ w_up)) @ w_down

    x = A_x
    h = x + _A_ref(_layernorm(x, axis=-1), A_wqkv, A_wo)
    h2 = h + _B_ref(_layernorm(h, axis=-1), B_w_gate, B_w_up, B_w_down)
    return h2
```

```asm
; @launch grid=(256,1,1) block=(512,1,1) lds=163840
.amdgcn_target "amdgcn-amd-amdhsa--gfx950"
.text
.globl sequential_preLN__softmax_full_mha__geglu_ffn__prompt_kernel
.p2align 8
.type sequential_preLN__softmax_full_mha__geglu_ffn__prompt_kernel,@function
sequential_preLN__softmax_full_mha__geglu_ffn__prompt_kernel:
    s_cmp_ge_u32 s2, 256
    s_cbranch_scc1 L_f_end
    s_load_dwordx2 s[8:9], s[0:1], 72
    s_load_dwordx2 s[4:5], s[0:1], 16
    s_load_dwordx4 s[24:27], s[0:1], 32
    s_load_dwordx2 s[6:7], s[0:1], 48
    s_load_dwordx2 s[10:11], s[0:1], 0
    s_load_dwordx2 s[16:17], s[0:1], 56
    s_load_dwordx2 s[100:101], s[0:1], 8
    s_load_dwordx2 s[96:97], s[0:1], 64
    v_lshrrev_b32 v3, 6, v0
    v_and_b32 v1, 63, v0
    v_readfirstlane_b32 s40, v3
    v_lshlrev_b32 v2, 4, v1
    s_lshr_b32 s19, s2, 3
    s_and_b32 s18, s2, 7
    s_and_b32 s41, s2, 7
    s_lshl_b32 s41, s41, 2
    s_lshr_b32 s43, s2, 6
    s_add_u32 s41, s41, s43
    s_lshr_b32 s42, s2, 3
    s_and_b32 s42, s42, 7
    s_lshr_b32 s43, s40, 2
    s_lshl_b32 s43, s43, 8
    v_xor_b32 v228, s43, v2
    v_lshlrev_b32 v229, 2, v1
    v_mov_b32 v233, 0
    v_lshlrev_b32 v234, 3, v1
    s_getreg_b32 s62, hwreg(HW_REG_XCC_ID)
    s_and_b32 s62, s62, 15
    s_add_u32 s62, s62, 1
    s_and_b32 s43, s40, 3
    s_mov_b32 s44, 0xffff0000
    v_lshrrev_b32 v3, 3, v1
    v_and_b32 v4, 7, v1
    v_lshrrev_b32 v5, 2, v1
    v_and_b32 v5, 4, v5
    v_xor_b32 v4, v4, v5
    v_mul_u32_u24 v6, 3072, v3
    v_lshl_add_u32 v14, v4, 4, v6
    v_lshlrev_b32 v3, 12, v3
    s_and_b32 s49, s43, 2
    v_xor_b32 v4, s49, v4
    v_xor_b32 v6, 0, v4
    v_lshl_add_u32 v10, v6, 4, v3
    v_xor_b32 v6, 1, v4
    v_lshl_add_u32 v11, v6, 4, v3
    s_and_b32 s50, s43, 1
    s_lshl_b32 s53, s50, 12
    s_lshl_b32 s45, s49, 10
    s_add_u32 s51, s53, s45
    s_lshl_b32 s46, s19, 1
    s_add_u32 s46, s46, s50
    s_lshl_b32 s47, s46, 15
    s_add_u32 s47, s47, s45
    v_lshlrev_b32 v3, 10, v1
    s_mul_i32 s45, s19, 48
    s_mul_i32 s46, s43, 12
    s_add_u32 s45, s45, s46
    s_lshl_b32 s45, s45, 10
    s_lshl_b32 s46, s18, 7
    s_add_u32 s45, s45, s46
    s_mul_i32 s48, s43, 49152
    s_add_u32 s48, s48, s46
    s_waitcnt lgkmcnt(0)
    s_mov_b32 s12, s10
    s_mov_b32 s13, s11
    s_mov_b32 s14, 0x200000
    s_mov_b32 s15, 0x00020000
    s_mov_b32 s28, s100
    s_mov_b32 s29, s101
    s_mov_b32 s30, 0x180000
    s_mov_b32 s31, 0x00020000
    s_cmp_ge_u32 s40, 4
    s_cbranch_scc1 L_p1_comp
    s_mov_b64 exec, 0xfff
    buffer_load_dword v9, v3, s[28:31], s45 offen
    s_mov_b64 exec, -1
    s_mul_i32 s52, s43, 6144
    s_add_u32 s52, s52, 65536
    s_add_u32 m0, s51, 0
    s_add_u32 s46, s47, 0
    buffer_load_dwordx4 v10, s[12:15], s46 offen offset:0 lds
    buffer_load_dwordx4 v11, s[12:15], s46 offen offset:1024 lds
    s_add_u32 m0, s52, 0
    s_add_u32 s45, s48, 0
    buffer_load_dwordx4 v14, s[28:31], s45 offen offset:0 lds
    buffer_load_dwordx4 v14, s[28:31], s45 offen offset:1024 lds
    buffer_load_dwordx4 v14, s[28:31], s45 offen offset:2048 lds
    s_add_u32 m0, m0, 3072
    s_add_u32 s45, s45, 24576
    buffer_load_dwordx4 v14, s[28:31], s45 offen offset:0 lds
    buffer_load_dwordx4 v14, s[28:31], s45 offen offset:1024 lds
    buffer_load_dwordx4 v14, s[28:31], s45 offen offset:2048 lds
    s_mov_b32 s20, s8
    s_mov_b32 s21, s9
    s_mov_b32 s22, 0x1c00000
    s_mov_b32 s23, 0x00020000
    s_mov_b32 s98, 256
    s_mov_b32 s99, 0x00020000
    s_lshl_b32 s54, s49, 1
    v_and_b32 v3, 31, v1
    v_and_b32 v4, 3, v1
    v_lshrrev_b32 v5, 2, v3
    v_lshlrev_b32 v5, 7, v5
    v_lshl_add_u32 v5, v4, 10, v5
    v_add_u32 v5, s53, v5
    v_lshrrev_b32 v6, 1, v3
    v_and_b32 v6, 4, v6
    v_or_b32 v6, v6, v4
    v_lshrrev_b32 v7, 5, v1
    v_xor_b32 v6, v6, v7
    v_xor_b32 v6, s54, v6
    v_xor_b32 v8, 0, v6
    v_lshl_add_u32 v15, v8, 4, v5
    v_xor_b32 v8, 2, v6
    v_lshl_add_u32 v16, v8, 4, v5
    v_xor_b32 v8, 4, v6
    v_lshl_add_u32 v17, v8, 4, v5
    v_xor_b32 v8, 6, v6
    v_lshl_add_u32 v18, v8, 4, v5
    v_lshrrev_b32 v3, 2, v1
    v_lshrrev_b32 v24, 4, v1
    v_xor_b32 v3, v3, v24
    v_and_b32 v3, 1, v3
    v_add_u32 v3, -1, v3
    v_and_b32 v24, 0x3f803f80, v3
    v_mov_b32 v25, v24
    v_mov_b32 v26, v24
    v_mov_b32 v27, v24
    v_mov_b32 v28, 0
    v_mov_b32 v29, 0
    v_mov_b32 v30, 0
    v_mov_b32 v31, 0
    v_mov_b32 v92, 0
    v_mov_b32 v93, 0
    v_mov_b32 v94, 0
    v_mov_b32 v95, 0
    s_add_u32 m0, s51, 8192
    s_add_u32 s46, s47, 128
    buffer_load_dwordx4 v10, s[12:15], s46 offen offset:0 lds
    buffer_load_dwordx4 v11, s[12:15], s46 offen offset:1024 lds
    s_add_u32 m0, s52, 24576
    s_add_u32 s45, s48, 196608
    buffer_load_dwordx4 v14, s[28:31], s45 offen offset:0 lds
    buffer_load_dwordx4 v14, s[28:31], s45 offen offset:1024 lds
    buffer_load_dwordx4 v14, s[28:31], s45 offen offset:2048 lds
    s_add_u32 m0, m0, 3072
    s_add_u32 s45, s45, 24576
    buffer_load_dwordx4 v14, s[28:31], s45 offen offset:0 lds
    buffer_load_dwordx4 v14, s[28:31], s45 offen offset:1024 lds
    buffer_load_dwordx4 v14, s[28:31], s45 offen offset:2048 lds
    s_waitcnt vmcnt(8)
    s_barrier
    ds_read_b128 v[64:67], v15 offset:0
    ds_read_b128 v[68:71], v16 offset:0
    s_add_u32 m0, s51, 16384
    s_add_u32 s46, s47, 256
    buffer_load_dwordx4 v10, s[12:15], s46 offen offset:0 lds
    buffer_load_dwordx4 v11, s[12:15], s46 offen offset:1024 lds
    s_add_u32 m0, s52, 49152
    s_add_u32 s45, s48, 393216
    buffer_load_dwordx4 v14, s[28:31], s45 offen offset:0 lds
    buffer_load_dwordx4 v14, s[28:31], s45 offen offset:1024 lds
    buffer_load_dwordx4 v14, s[28:31], s45 offen offset:2048 lds
    s_add_u32 m0, m0, 3072
    s_add_u32 s45, s45, 24576
    buffer_load_dwordx4 v14, s[28:31], s45 offen offset:0 lds
    buffer_load_dwordx4 v14, s[28:31], s45 offen offset:1024 lds
    buffer_load_dwordx4 v14, s[28:31], s45 offen offset:2048 lds
    s_waitcnt lgkmcnt(1)
    v_lshlrev_b32 v124, 16, v64
    v_and_b32 v125, s44, v64
    v_lshlrev_b32 v126, 16, v65
    v_and_b32 v127, s44, v65
    v_lshlrev_b32 v128, 16, v66
    v_and_b32 v129, s44, v66
    v_lshlrev_b32 v130, 16, v67
    v_and_b32 v131, s44, v67
    v_fmac_f32 v28, v124, v124
    v_fmac_f32 v29, v125, v125
    v_fmac_f32 v30, v126, v126
    v_fmac_f32 v31, v127, v127
    v_fmac_f32 v28, v128, v128
    v_fmac_f32 v29, v129, v129
    v_fmac_f32 v30, v130, v130
    v_fmac_f32 v31, v131, v131
    s_waitcnt lgkmcnt(0)
    v_lshlrev_b32 v124, 16, v68
    v_and_b32 v125, s44, v68
    v_lshlrev_b32 v126, 16, v69
    v_and_b32 v127, s44, v69
    v_lshlrev_b32 v128, 16, v70
    v_and_b32 v129, s44, v70
    v_lshlrev_b32 v130, 16, v71
    v_and_b32 v131, s44, v71
    v_fmac_f32 v28, v124, v124
    v_fmac_f32 v29, v125, v125
    v_fmac_f32 v30, v126, v126
    v_fmac_f32 v31, v127, v127
    v_fmac_f32 v28, v128, v128
    v_fmac_f32 v29, v129, v129
    v_fmac_f32 v30, v130, v130
    v_fmac_f32 v31, v131, v131
    v_mfma_f32_16x16x32_bf16 v[92:95], v[24:27], v[64:67], v[92:95]
    v_mfma_f32_16x16x32_bf16 v[92:95], v[24:27], v[68:71], v[92:95]
    s_waitcnt vmcnt(8)
    s_barrier
    ds_read_b128 v[64:67], v15 offset:8192
    ds_read_b128 v[68:71], v16 offset:8192
    s_add_u32 m0, s51, 24576
    s_add_u32 s46, s47, 384
    buffer_load_dwordx4 v10, s[12:15], s46 offen offset:0 lds
    buffer_load_dwordx4 v11, s[12:15], s46 offen offset:1024 lds
    s_add_u32 m0, s52, 0
    s_add_u32 s45, s48, 589824
    buffer_load_dwordx4 v14, s[28:31], s45 offen offset:0 lds
    buffer_load_dwordx4 v14, s[28:31], s45 offen offset:1024 lds
    buffer_load_dwordx4 v14, s[28:31], s45 offen offset:2048 lds
    s_add_u32 m0, m0, 3072
    s_add_u32 s45, s45, 24576
    buffer_load_dwordx4 v14, s[28:31], s45 offen offset:0 lds
    buffer_load_dwordx4 v14, s[28:31], s45 offen offset:1024 lds
    buffer_load_dwordx4 v14, s[28:31], s45 offen offset:2048 lds
    s_waitcnt lgkmcnt(1)
    v_lshlrev_b32 v124, 16, v64
    v_and_b32 v125, s44, v64
    v_lshlrev_b32 v126, 16, v65
    v_and_b32 v127, s44, v65
    v_lshlrev_b32 v128, 16, v66
    v_and_b32 v129, s44, v66
    v_lshlrev_b32 v130, 16, v67
    v_and_b32 v131, s44, v67
    v_fmac_f32 v28, v124, v124
    v_fmac_f32 v29, v125, v125
    v_fmac_f32 v30, v126, v126
    v_fmac_f32 v31, v127, v127
    v_fmac_f32 v28, v128, v128
    v_fmac_f32 v29, v129, v129
    v_fmac_f32 v30, v130, v130
    v_fmac_f32 v31, v131, v131
    s_waitcnt lgkmcnt(0)
    v_lshlrev_b32 v124, 16, v68
    v_and_b32 v125, s44, v68
    v_lshlrev_b32 v126, 16, v69
    v_and_b32 v127, s44, v69
    v_lshlrev_b32 v128, 16, v70
    v_and_b32 v129, s44, v70
    v_lshlrev_b32 v130, 16, v71
    v_and_b32 v131, s44, v71
    v_fmac_f32 v28, v124, v124
    v_fmac_f32 v29, v125, v125
    v_fmac_f32 v30, v126, v126
    v_fmac_f32 v31, v127, v127
    v_fmac_f32 v28, v128, v128
    v_fmac_f32 v29, v129, v129
    v_fmac_f32 v30, v130, v130
    v_fmac_f32 v31, v131, v131
    v_mfma_f32_16x16x32_bf16 v[92:95], v[24:27], v[64:67], v[92:95]
    v_mfma_f32_16x16x32_bf16 v[92:95], v[24:27], v[68:71], v[92:95]
    s_waitcnt vmcnt(8)
    s_barrier
    ds_read_b128 v[64:67], v15 offset:16384
    ds_read_b128 v[68:71], v16 offset:16384
    s_add_u32 m0, s51, 32768
    s_add_u32 s46, s47, 512
    buffer_load_dwordx4 v10, s[12:15], s46 offen offset:0 lds
    buffer_load_dwordx4 v11, s[12:15], s46 offen offset:1024 lds
    s_add_u32 m0, s52, 24576
    s_add_u32 s45, s48, 786432
    buffer_load_dwordx4 v14, s[28:31], s45 offen offset:0 lds
    buffer_load_dwordx4 v14, s[28:31], s45 offen offset:1024 lds
    buffer_load_dwordx4 v14, s[28:31], s45 offen offset:2048 lds
    s_add_u32 m0, m0, 3072
    s_add_u32 s45, s45, 24576
    buffer_load_dwordx4 v14, s[28:31], s45 offen offset:0 lds
    buffer_load_dwordx4 v14, s[28:31], s45 offen offset:1024 lds
    buffer_load_dwordx4 v14, s[28:31], s45 offen offset:2048 lds
    s_waitcnt lgkmcnt(1)
    v_lshlrev_b32 v124, 16, v64
    v_and_b32 v125, s44, v64
    v_lshlrev_b32 v126, 16, v65
    v_and_b32 v127, s44, v65
    v_lshlrev_b32 v128, 16, v66
    v_and_b32 v129, s44, v66
    v_lshlrev_b32 v130, 16, v67
    v_and_b32 v131, s44, v67
    v_fmac_f32 v28, v124, v124
    v_fmac_f32 v29, v125, v125
    v_fmac_f32 v30, v126, v126
    v_fmac_f32 v31, v127, v127
    v_fmac_f32 v28, v128, v128
    v_fmac_f32 v29, v129, v129
    v_fmac_f32 v30, v130, v130
    v_fmac_f32 v31, v131, v131
    s_waitcnt lgkmcnt(0)
    v_lshlrev_b32 v124, 16, v68
    v_and_b32 v125, s44, v68
    v_lshlrev_b32 v126, 16, v69
    v_and_b32 v127, s44, v69
    v_lshlrev_b32 v128, 16, v70
    v_and_b32 v129, s44, v70
    v_lshlrev_b32 v130, 16, v71
    v_and_b32 v131, s44, v71
    v_fmac_f32 v28, v124, v124
    v_fmac_f32 v29, v125, v125
    v_fmac_f32 v30, v126, v126
    v_fmac_f32 v31, v127, v127
    v_fmac_f32 v28, v128, v128
    v_fmac_f32 v29, v129, v129
    v_fmac_f32 v30, v130, v130
    v_fmac_f32 v31, v131, v131
    v_mfma_f32_16x16x32_bf16 v[92:95], v[24:27], v[64:67], v[92:95]
    v_mfma_f32_16x16x32_bf16 v[92:95], v[24:27], v[68:71], v[92:95]
    s_waitcnt vmcnt(8)
    s_barrier
    ds_read_b128 v[64:67], v15 offset:24576
    ds_read_b128 v[68:71], v16 offset:24576
    s_add_u32 m0, s51, 40960
    s_add_u32 s46, s47, 640
    buffer_load_dwordx4 v10, s[12:15], s46 offen offset:0 lds
    buffer_load_dwordx4 v11, s[12:15], s46 offen offset:1024 lds
    s_add_u32 m0, s52, 49152
    s_add_u32 s45, s48, 983040
    buffer_load_dwordx4 v14, s[28:31], s45 offen offset:0 lds
    buffer_load_dwordx4 v14, s[28:31], s45 offen offset:1024 lds
    buffer_load_dwordx4 v14, s[28:31], s45 offen offset:2048 lds
    s_add_u32 m0, m0, 3072
    s_add_u32 s45, s45, 24576
    buffer_load_dwordx4 v14, s[28:31], s45 offen offset:0 lds
    buffer_load_dwordx4 v14, s[28:31], s45 offen offset:1024 lds
    buffer_load_dwordx4 v14, s[28:31], s45 offen offset:2048 lds
    s_waitcnt lgkmcnt(1)
    v_lshlrev_b32 v124, 16, v64
    v_and_b32 v125, s44, v64
    v_lshlrev_b32 v126, 16, v65
    v_and_b32 v127, s44, v65
    v_lshlrev_b32 v128, 16, v66
    v_and_b32 v129, s44, v66
    v_lshlrev_b32 v130, 16, v67
    v_and_b32 v131, s44, v67
    v_fmac_f32 v28, v124, v124
    v_fmac_f32 v29, v125, v125
    v_fmac_f32 v30, v126, v126
    v_fmac_f32 v31, v127, v127
    v_fmac_f32 v28, v128, v128
    v_fmac_f32 v29, v129, v129
    v_fmac_f32 v30, v130, v130
    v_fmac_f32 v31, v131, v131
    s_waitcnt lgkmcnt(0)
    v_lshlrev_b32 v124, 16, v68
    v_and_b32 v125, s44, v68
    v_lshlrev_b32 v126, 16, v69
    v_and_b32 v127, s44, v69
    v_lshlrev_b32 v128, 16, v70
    v_and_b32 v129, s44, v70
    v_lshlrev_b32 v130, 16, v71
    v_and_b32 v131, s44, v71
    v_fmac_f32 v28, v124, v124
    v_fmac_f32 v29, v125, v125
    v_fmac_f32 v30, v126, v126
    v_fmac_f32 v31, v127, v127
    v_fmac_f32 v28, v128, v128
    v_fmac_f32 v29, v129, v129
    v_fmac_f32 v30, v130, v130
    v_fmac_f32 v31, v131, v131
    v_mfma_f32_16x16x32_bf16 v[92:95], v[24:27], v[64:67], v[92:95]
    v_mfma_f32_16x16x32_bf16 v[92:95], v[24:27], v[68:71], v[92:95]
    s_waitcnt vmcnt(8)
    s_barrier
    ds_read_b128 v[64:67], v15 offset:32768
    ds_read_b128 v[68:71], v16 offset:32768
    s_add_u32 m0, s51, 49152
    s_add_u32 s46, s47, 768
    buffer_load_dwordx4 v10, s[12:15], s46 offen offset:0 lds
    buffer_load_dwordx4 v11, s[12:15], s46 offen offset:1024 lds
    s_add_u32 m0, s52, 0
    s_add_u32 s45, s48, 1179648
    buffer_load_dwordx4 v14, s[28:31], s45 offen offset:0 lds
    buffer_load_dwordx4 v14, s[28:31], s45 offen offset:1024 lds
    buffer_load_dwordx4 v14, s[28:31], s45 offen offset:2048 lds
    s_add_u32 m0, m0, 3072
    s_add_u32 s45, s45, 24576
    buffer_load_dwordx4 v14, s[28:31], s45 offen offset:0 lds
    buffer_load_dwordx4 v14, s[28:31], s45 offen offset:1024 lds
    buffer_load_dwordx4 v14, s[28:31], s45 offen offset:2048 lds
    s_waitcnt lgkmcnt(1)
    v_lshlrev_b32 v124, 16, v64
    v_and_b32 v125, s44, v64
    v_lshlrev_b32 v126, 16, v65
    v_and_b32 v127, s44, v65
    v_lshlrev_b32 v128, 16, v66
    v_and_b32 v129, s44, v66
    v_lshlrev_b32 v130, 16, v67
    v_and_b32 v131, s44, v67
    v_fmac_f32 v28, v124, v124
    v_fmac_f32 v29, v125, v125
    v_fmac_f32 v30, v126, v126
    v_fmac_f32 v31, v127, v127
    v_fmac_f32 v28, v128, v128
    v_fmac_f32 v29, v129, v129
    v_fmac_f32 v30, v130, v130
    v_fmac_f32 v31, v131, v131
    s_waitcnt lgkmcnt(0)
    v_lshlrev_b32 v124, 16, v68
    v_and_b32 v125, s44, v68
    v_lshlrev_b32 v126, 16, v69
    v_and_b32 v127, s44, v69
    v_lshlrev_b32 v128, 16, v70
    v_and_b32 v129, s44, v70
    v_lshlrev_b32 v130, 16, v71
    v_and_b32 v131, s44, v71
    v_fmac_f32 v28, v124, v124
    v_fmac_f32 v29, v125, v125
    v_fmac_f32 v30, v126, v126
    v_fmac_f32 v31, v127, v127
    v_fmac_f32 v28, v128, v128
    v_fmac_f32 v29, v129, v129
    v_fmac_f32 v30, v130, v130
    v_fmac_f32 v31, v131, v131
    v_mfma_f32_16x16x32_bf16 v[92:95], v[24:27], v[64:67], v[92:95]
    v_mfma_f32_16x16x32_bf16 v[92:95], v[24:27], v[68:71], v[92:95]
    s_waitcnt vmcnt(8)
    s_barrier
    ds_read_b128 v[64:67], v15 offset:40960
    ds_read_b128 v[68:71], v16 offset:40960
    s_add_u32 m0, s51, 57344
    s_add_u32 s46, s47, 896
    buffer_load_dwordx4 v10, s[12:15], s46 offen offset:0 lds
    buffer_load_dwordx4 v11, s[12:15], s46 offen offset:1024 lds
    s_add_u32 m0, s52, 24576
    s_add_u32 s45, s48, 1376256
    buffer_load_dwordx4 v14, s[28:31], s45 offen offset:0 lds
    buffer_load_dwordx4 v14, s[28:31], s45 offen offset:1024 lds
    buffer_load_dwordx4 v14, s[28:31], s45 offen offset:2048 lds
    s_add_u32 m0, m0, 3072
    s_add_u32 s45, s45, 24576
    buffer_load_dwordx4 v14, s[28:31], s45 offen offset:0 lds
    buffer_load_dwordx4 v14, s[28:31], s45 offen offset:1024 lds
    buffer_load_dwordx4 v14, s[28:31], s45 offen offset:2048 lds
    s_lshr_b32 s45, s43, 1
    s_lshl_b32 s46, s19, 1
    s_add_u32 s45, s45, s46
    s_lshl_b32 s45, s45, 10
    s_lshl_b32 s46, s18, 1
    s_add_u32 s46, s46, s50
    s_lshl_b32 s46, s46, 17
    s_add_u32 s45, s45, s46
    s_add_u32 s46, s45, 2097152
    buffer_load_dwordx4 v[160:163], v2, s[20:23], s46 offen sc1
    s_add_u32 s46, s45, 2162688
    buffer_load_dwordx4 v[164:167], v2, s[20:23], s46 offen sc1
    s_add_u32 s46, s45, 4194304
    buffer_load_dwordx4 v[168:171], v2, s[20:23], s46 offen sc1
    s_add_u32 s46, s45, 4259840
    buffer_load_dwordx4 v[172:175], v2, s[20:23], s46 offen sc1
    s_add_u32 s46, s45, 0
    buffer_load_dwordx4 v[176:179], v2, s[20:23], s46 offen sc1
    s_add_u32 s46, s45, 65536
    buffer_load_dwordx4 v[180:183], v2, s[20:23], s46 offen sc1
    s_waitcnt lgkmcnt(1)
    v_lshlrev_b32 v124, 16, v64
    v_and_b32 v125, s44, v64
    v_lshlrev_b32 v126, 16, v65
    v_and_b32 v127, s44, v65
    v_lshlrev_b32 v128, 16, v66
    v_and_b32 v129, s44, v66
    v_lshlrev_b32 v130, 16, v67
    v_and_b32 v131, s44, v67
    v_fmac_f32 v28, v124, v124
    v_fmac_f32 v29, v125, v125
    v_fmac_f32 v30, v126, v126
    v_fmac_f32 v31, v127, v127
    v_fmac_f32 v28, v128, v128
    v_fmac_f32 v29, v129, v129
    v_fmac_f32 v30, v130, v130
    v_fmac_f32 v31, v131, v131
    s_waitcnt lgkmcnt(0)
    v_lshlrev_b32 v124, 16, v68
    v_and_b32 v125, s44, v68
    v_lshlrev_b32 v126, 16, v69
    v_and_b32 v127, s44, v69
    v_lshlrev_b32 v128, 16, v70
    v_and_b32 v129, s44, v70
    v_lshlrev_b32 v130, 16, v71
    v_and_b32 v131, s44, v71
    v_fmac_f32 v28, v124, v124
    v_fmac_f32 v29, v125, v125
    v_fmac_f32 v30, v126, v126
    v_fmac_f32 v31, v127, v127
    v_fmac_f32 v28, v128, v128
    v_fmac_f32 v29, v129, v129
    v_fmac_f32 v30, v130, v130
    v_fmac_f32 v31, v131, v131
    v_mfma_f32_16x16x32_bf16 v[92:95], v[24:27], v[64:67], v[92:95]
    v_mfma_f32_16x16x32_bf16 v[92:95], v[24:27], v[68:71], v[92:95]
    s_waitcnt vmcnt(14)
    s_barrier
    ds_read_b128 v[64:67], v15 offset:49152
    ds_read_b128 v[68:71], v16 offset:49152
    s_waitcnt lgkmcnt(1)
    v_lshlrev_b32 v124, 16, v64
    v_and_b32 v125, s44, v64
    v_lshlrev_b32 v126, 16, v65
    v_and_b32 v127, s44, v65
    v_lshlrev_b32 v128, 16, v66
    v_and_b32 v129, s44, v66
    v_lshlrev_b32 v130, 16, v67
    v_and_b32 v131, s44, v67
    v_fmac_f32 v28, v124, v124
    v_fmac_f32 v29, v125, v125
    v_fmac_f32 v30, v126, v126
    v_fmac_f32 v31, v127, v127
    v_fmac_f32 v28, v128, v128
    v_fmac_f32 v29, v129, v129
    v_fmac_f32 v30, v130, v130
    v_fmac_f32 v31, v131, v131
    s_waitcnt lgkmcnt(0)
    v_lshlrev_b32 v124, 16, v68
    v_and_b32 v125, s44, v68
    v_lshlrev_b32 v126, 16, v69
    v_and_b32 v127, s44, v69
    v_lshlrev_b32 v128, 16, v70
    v_and_b32 v129, s44, v70
    v_lshlrev_b32 v130, 16, v71
    v_and_b32 v131, s44, v71
    v_fmac_f32 v28, v124, v124
    v_fmac_f32 v29, v125, v125
    v_fmac_f32 v30, v126, v126
    v_fmac_f32 v31, v127, v127
    v_fmac_f32 v28, v128, v128
    v_fmac_f32 v29, v129, v129
    v_fmac_f32 v30, v130, v130
    v_fmac_f32 v31, v131, v131
    v_mfma_f32_16x16x32_bf16 v[92:95], v[24:27], v[64:67], v[92:95]
    v_mfma_f32_16x16x32_bf16 v[92:95], v[24:27], v[68:71], v[92:95]
    s_waitcnt vmcnt(6)
    s_barrier
    ds_read_b128 v[64:67], v15 offset:57344
    ds_read_b128 v[68:71], v16 offset:57344
    s_waitcnt lgkmcnt(1)
    v_lshlrev_b32 v124, 16, v64
    v_and_b32 v125, s44, v64
    v_lshlrev_b32 v126, 16, v65
    v_and_b32 v127, s44, v65
    v_lshlrev_b32 v128, 16, v66
    v_and_b32 v129, s44, v66
    v_lshlrev_b32 v130, 16, v67
    v_and_b32 v131, s44, v67
    v_fmac_f32 v28, v124, v124
    v_fmac_f32 v29, v125, v125
    v_fmac_f32 v30, v126, v126
    v_fmac_f32 v31, v127, v127
    v_fmac_f32 v28, v128, v128
    v_fmac_f32 v29, v129, v129
    v_fmac_f32 v30, v130, v130
    v_fmac_f32 v31, v131, v131
    s_waitcnt lgkmcnt(0)
    v_lshlrev_b32 v124, 16, v68
    v_and_b32 v125, s44, v68
    v_lshlrev_b32 v126, 16, v69
    v_and_b32 v127, s44, v69
    v_lshlrev_b32 v128, 16, v70
    v_and_b32 v129, s44, v70
    v_lshlrev_b32 v130, 16, v71
    v_and_b32 v131, s44, v71
    v_fmac_f32 v28, v124, v124
    v_fmac_f32 v29, v125, v125
    v_fmac_f32 v30, v126, v126
    v_fmac_f32 v31, v127, v127
    v_fmac_f32 v28, v128, v128
    v_fmac_f32 v29, v129, v129
    v_fmac_f32 v30, v130, v130
    v_fmac_f32 v31, v131, v131
    v_mfma_f32_16x16x32_bf16 v[92:95], v[24:27], v[64:67], v[92:95]
    v_mfma_f32_16x16x32_bf16 v[92:95], v[24:27], v[68:71], v[92:95]
    s_nop 1
    v_add_f32 v28, v28, v29
    v_add_f32 v30, v30, v31
    v_add_f32 v28, v28, v30
    v_mov_b32 v29, v28
    s_nop 1
    v_permlane32_swap_b32 v28, v29
    s_nop 1
    v_add_f32 v28, v28, v29
    v_mov_b32 v29, v92
    s_lshl_b32 s45, s50, 9
    s_add_u32 s45, s45, 143360
    v_lshl_add_u32 v6, v1, 3, s45
    s_cmp_lt_u32 s40, 2
    s_cbranch_scc1 L_p1_fin
    ds_write_b64 v6, v[28:29]
    s_waitcnt lgkmcnt(0)
    s_barrier
    s_branch L_p1_hx
L_p1_fin:
    v_and_b32 v3, 31, v1
    v_lshlrev_b32 v3, 2, v3
    s_barrier
    ds_read_b64 v[30:31], v6
    s_lshl_b32 s45, s43, 7
    s_add_u32 s45, s45, 140800
    v_add_u32 v5, s45, v3
    s_lshl_b32 s45, s43, 9
    s_add_u32 s45, s45, 141312
    v_lshl_add_u32 v6, v1, 3, s45
    s_waitcnt lgkmcnt(0)
    v_add_f32 v28, v28, v30
    v_add_f32 v29, v29, v31
    v_mul_f32 v30, 0x3b000000, v29
    v_mul_f32 v28, 0x3b000000, v28
    v_fma_f32 v28, -v30, v30, v28
    v_max_f32 v28, 0, v28
    v_add_f32 v28, 0x3727c5ac, v28
    v_rsq_f32 v31, v28
    v_sub_f32 v30, 0, v30
    v_cvt_pk_bf16_f32 v64, v30, v30
    v_and_b32 v7, s44, v64
    v_sub_f32 v7, v30, v7
    v_cvt_pk_bf16_f32 v65, v7, v7
    v_mov_b32 v66, 0
    v_mov_b32 v67, 0
    ds_write_b32 v5, v31
    ds_write_b64 v6, v[64:65]
    s_waitcnt lgkmcnt(0)
L_p1_hx:
    s_barrier
    s_lshl_b32 s38, s18, 5
    s_mov_b32 s36, 0
L_tc_h:
    buffer_load_dword v230, v229, s[96:99], s38 offen sc1
L_tc_h_w:
    s_add_u32 s36, s36, 1
    s_waitcnt vmcnt(0)
    v_subrev_u32 v231, 0x01010101, v230
    v_not_b32 v232, v230
    v_and_b32 v231, v231, v232
    v_and_b32 v231, 0x80808080, v231
    v_cmp_eq_u32 vcc, 0, v231
    s_cmp_gt_u32 s36, 0x40000
    s_cbranch_scc1 L_tc_h_d
    s_and_b32 s37, vcc_lo, 0xff
    s_cmp_lg_u32 s37, 0xff
    s_cbranch_scc1 L_tc_h
L_tc_h_d:
    s_mul_i32 s37, s62, 0x01010101
    v_cmp_eq_u32 vcc, s37, v230
    s_nop 3
    s_or_b32 s63, vcc_lo, 0xffffff00
    s_cmp_lg_u32 s40, 0
    s_cbranch_scc1 L_p1_done
    s_lshl_b32 s32, s18, 9
    s_bfe_u32 s33, s41, 0x10001
    s_lshl_b32 s33, s33, 8
    s_add_u32 s32, s32, s33
    s_add_u32 s32, s32, 29122560
    s_mov_b32 s36, 0
L_poll_f1:
    buffer_load_dword v230, v229, s[20:23], s32 offen sc1
    s_add_u32 s36, s36, 1
    s_waitcnt vmcnt(0)
    v_cmp_ne_u32 vcc, 0, v230
    s_cmp_gt_u32 s36, 0x40000
    s_cbranch_scc1 L_polld_f1
    s_and_b32 s37, vcc_lo, vcc_hi
    s_cmp_lg_u32 s37, -1
    s_cbranch_scc1 L_poll_f1
L_polld_f1:
    s_branch L_p1_done
L_p1_comp:
    v_mov_b32 v200, v10
    v_mov_b32 v201, v11
    s_lshr_b32 s55, s43, 1
    s_and_b32 s56, s43, 1
    s_lshl_b32 s45, s55, 12
    s_lshl_b32 s46, s55, 1
    v_and_b32 v3, 31, v1
    v_and_b32 v4, 3, v1
    v_lshrrev_b32 v5, 2, v3
    v_lshlrev_b32 v5, 7, v5
    v_lshl_add_u32 v5, v4, 10, v5
    v_add_u32 v5, s45, v5
    v_lshrrev_b32 v6, 1, v3
    v_and_b32 v6, 4, v6
    v_or_b32 v6, v6, v4
    v_lshrrev_b32 v7, 5, v1
    v_xor_b32 v6, v6, v7
    v_xor_b32 v6, s46, v6
    v_xor_b32 v8, 0, v6
    v_lshl_add_u32 v15, v8, 4, v5
    v_xor_b32 v8, 2, v6
    v_lshl_add_u32 v16, v8, 4, v5
    v_xor_b32 v8, 4, v6
    v_lshl_add_u32 v17, v8, 4, v5
    v_xor_b32 v8, 6, v6
    v_lshl_add_u32 v18, v8, 4, v5
    v_bfe_u32 v3, v1, 2, 2
    v_lshlrev_b32 v4, 7, v3
    v_lshrrev_b32 v3, 1, v3
    v_xor_b32 v3, s56, v3
    v_lshl_add_u32 v4, v3, 6, v4
    v_bfe_u32 v3, v1, 4, 1
    v_lshl_add_u32 v4, v3, 5, v4
    v_and_b32 v3, 3, v1
    v_lshl_add_u32 v4, v3, 3, v4
    v_lshrrev_b32 v5, 5, v1
    v_mul_u32_u24 v3, 3072, v5
    v_add_u32 v4, v4, v3
    s_xor_b32 s45, s55, 0
    s_mul_i32 s45, s45, 6144
    s_add_u32 s45, s45, 65536
    v_add_u32 v19, s45, v4
    v_add_u32 v22, 49152, v19
    s_xor_b32 s45, s55, 1
    s_mul_i32 s45, s45, 6144
    s_add_u32 s45, s45, 65536
    v_add_u32 v20, s45, v4
    v_add_u32 v23, 49152, v20
    v_lshrrev_b32 v3, 2, v1
    v_lshrrev_b32 v24, 4, v1
    v_xor_b32 v3, v3, v24
    v_and_b32 v3, 1, v3
    v_add_u32 v3, -1, v3
    v_and_b32 v24, 0x3f803f80, v3
    v_mov_b32 v25, v24
    v_mov_b32 v26, v24
    v_mov_b32 v27, v24
    v_and_b32 v3, 31, v1
    v_lshlrev_b32 v3, 2, v3
    s_mul_i32 s45, s56, 768
    s_add_u32 s45, s45, 139264
    v_mul_u32_u24 v6, 384, v5
    v_add3_u32 v11, v6, v3, s45
    s_mul_i32 s46, s55, 384
    s_add_u32 s45, s45, s46
    v_add_u32 v10, s45, v3
    s_lshl_b32 s45, s55, 7
    s_add_u32 s45, s45, 140800
    v_add_u32 v12, s45, v3
    v_lshl_add_u32 v13, v5, 4, s45
    s_lshl_b32 s45, s55, 9
    s_add_u32 s45, s45, 141312
    v_lshl_add_u32 v14, v1, 3, s45
    v_bfe_u32 v4, v1, 4, 1
    v_lshlrev_b32 v4, 16, v4
    v_lshl_add_u32 v4, v5, 8, v4
    v_and_b32 v5, 15, v1
    v_lshl_add_u32 v21, v5, 4, v4
    s_lshl_b32 s45, s19, 1
    s_add_u32 s45, s45, s55
    s_lshl_b32 s45, s45, 10
    s_lshl_b32 s46, s18, 1
    s_add_u32 s46, s46, s56
    s_lshl_b32 s46, s46, 17
    s_add_u32 s57, s45, s46
    s_add_u32 s58, s57, 65536
    s_add_u32 s59, s57, 2097152
    s_add_u32 s60, s58, 2097152
    s_add_u32 s61, s57, 4194304
    v_mov_b32 v126, 0
    v_mov_b32 v127, 0
    s_waitcnt lgkmcnt(0)
    s_mov_b32 s20, s8
    s_mov_b32 s21, s9
    s_mov_b32 s22, 0x1c00000
    s_mov_b32 s23, 0x00020000
    s_mov_b32 s98, 256
    s_mov_b32 s99, 0x00020000
    s_cmp_lg_u32 s40, 4
    s_cbranch_scc1 L_p1_nz
    v_and_b32 v144, 1, v1
    v_bfe_u32 v145, v1, 1, 1
    v_bfe_u32 v146, v1, 2, 1
    v_bfe_u32 v147, v1, 1, 2
    s_lshl_b32 s36, s42, 10
    s_lshl_b32 s37, s41, 2
    s_add_u32 s36, s36, s37
    v_lshl_add_u32 v148, v147, 8, s36
    v_lshl_add_u32 v148, v144, 7, v148
    s_and_b32 s36, s19, 3
    s_lshl_b32 s37, s18, 2
    s_add_u32 s38, s36, s37
    s_lshl_b32 s36, s38, 8
    s_lshr_b32 s37, s19, 2
    s_lshl_b32 s39, s37, 4
    s_add_u32 s36, s36, s39
    s_add_u32 s36, s36, 8192
    v_lshl_add_u32 v149, v145, 7, s36
    v_lshl_add_u32 v149, v144, 3, v149
    v_lshl_add_u32 v149, v146, 2, v149
    s_lshr_b32 s36, s38, 1
    s_lshl_b32 s36, s36, 8
    s_lshl_b32 s37, s37, 1
    s_and_b32 s39, s19, 1
    s_add_u32 s37, s37, s39
    s_lshl_b32 s37, s37, 2
    s_add_u32 s36, s36, s37
    s_add_u32 s36, s36, 16384
    v_lshl_add_u32 v150, v145, 7, s36
    v_lshl_add_u32 v150, v144, 6, v150
    s_lshl_b32 s36, s2, 4
    s_add_u32 s36, s36, 20480
    v_and_b32 v151, 3, v1
    v_lshl_add_u32 v151, v151, 2, s36
    v_cmp_ne_u32 vcc, 0, v146
    s_lshl_b32 s36, s18, 9
    s_lshl_b32 s37, s19, 3
    s_add_u32 s36, s36, s37
    s_add_u32 s36, s36, 24576
    v_cndmask_b32 v150, v150, v151, vcc
    v_lshl_add_u32 v151, v144, 8, s36
    v_lshl_add_u32 v151, v145, 2, v151
    v_mov_b32 v3, v148
    v_cmp_le_u32 vcc, 8, v1
    s_nop 1
    v_cndmask_b32 v3, v3, v149, vcc
    v_cmp_le_u32 vcc, 16, v1
    s_nop 1
    v_cndmask_b32 v3, v3, v150, vcc
    v_cmp_le_u32 vcc, 24, v1
    s_nop 1
    v_cndmask_b32 v3, v3, v151, vcc
    v_mov_b32 v4, 0
    s_mov_b32 s45, 29097984
    s_mov_b64 exec, 0xffffffff
    buffer_store_dword v4, v3, s[20:23], s45 offen sc1
    s_mov_b64 exec, -1
L_p1_nz:
    s_barrier
    ds_read_b128 v[32:35], v15 offset:0
    ds_read_b64_tr_b16 v[40:41], v19 offset:0
    ds_read_b64_tr_b16 v[42:43], v19 offset:512
    ds_read_b64_tr_b16 v[44:45], v19 offset:1024
    ds_read_b64_tr_b16 v[46:47], v19 offset:1536
    ds_read_b64_tr_b16 v[48:49], v19 offset:2048
    ds_read_b64_tr_b16 v[50:51], v19 offset:2560
    ds_read_b128 v[36:39], v16 offset:0
    ds_read_b64_tr_b16 v[52:53], v20 offset:0
    ds_read_b64_tr_b16 v[54:55], v20 offset:512
    ds_read_b64_tr_b16 v[56:57], v20 offset:1024
    ds_read_b64_tr_b16 v[58:59], v20 offset:1536
    ds_read_b64_tr_b16 v[60:61], v20 offset:2048
    ds_read_b64_tr_b16 v[62:63], v20 offset:2560
    s_waitcnt lgkmcnt(11)
    v_mfma_f32_32x32x16_bf16 v[64:79], v[40:43], v[32:35], 0
    ds_read_b128 v[184:187], v17 offset:0
    ds_read_b64_tr_b16 v[188:189], v19 offset:12288
    ds_read_b64_tr_b16 v[190:191], v19 offset:12800
    s_waitcnt lgkmcnt(12)
    v_mfma_f32_32x32x16_bf16 v[80:95], v[44:47], v[32:35], 0
    ds_read_b64_tr_b16 v[192:193], v19 offset:13312
    ds_read_b64_tr_b16 v[194:195], v19 offset:13824
    ds_read_b64_tr_b16 v[196:197], v19 offset:14336
    s_waitcnt lgkmcnt(13)
    v_mfma_f32_32x32x16_bf16 v[96:111], v[32:35], v[48:51], 0
    ds_read_b64_tr_b16 v[198:199], v19 offset:14848
    v_mfma_f32_16x16x32_bf16 v[112:115], v[24:27], v[40:43], 0
    v_mfma_f32_16x16x32_bf16 v[116:119], v[24:27], v[44:47], 0
    v_mfma_f32_16x16x32_bf16 v[120:123], v[24:27], v[48:51], 0
    s_waitcnt lgkmcnt(11)
    v_mfma_f32_32x32x16_bf16 v[64:79], v[52:55], v[36:39], v[64:79]
    ds_read_b128 v[32:35], v18 offset:0
    ds_read_b64_tr_b16 v[40:41], v20 offset:12288
    ds_read_b64_tr_b16 v[42:43], v20 offset:12800
    s_waitcnt lgkmcnt(12)
    v_mfma_f32_32x32x16_bf16 v[80:95], v[56:59], v[36:39], v[80:95]
    ds_read_b64_tr_b16 v[44:45], v20 offset:13312
    ds_read_b64_tr_b16 v[46:47], v20 offset:13824
    ds_read_b64_tr_b16 v[48:49], v20 offset:14336
    s_waitcnt lgkmcnt(13)
    v_mfma_f32_32x32x16_bf16 v[96:111], v[36:39], v[60:63], v[96:111]
    ds_read_b64_tr_b16 v[50:51], v20 offset:14848
    s_waitcnt lgkmcnt(11)
    v_mfma_f32_32x32x16_bf16 v[64:79], v[188:191], v[184:187], v[64:79]
    s_waitcnt lgkmcnt(0)
    s_barrier
    ds_read_b128 v[36:39], v15 offset:8192
    ds_read_b64_tr_b16 v[52:53], v19 offset:24576
    ds_read_b64_tr_b16 v[54:55], v19 offset:25088
    v_mfma_f32_32x32x16_bf16 v[80:95], v[192:195], v[184:187], v[80:95]
    ds_read_b64_tr_b16 v[56:57], v19 offset:25600
    ds_read_b64_tr_b16 v[58:59], v19 offset:26112
    ds_read_b64_tr_b16 v[60:61], v19 offset:26624
    v_mfma_f32_32x32x16_bf16 v[96:111], v[184:187], v[196:199], v[96:111]
    ds_read_b64_tr_b16 v[62:63], v19 offset:27136
    v_mfma_f32_16x16x32_bf16 v[112:115], v[24:27], v[188:191], v[112:115]
    v_mfma_f32_16x16x32_bf16 v[116:119], v[24:27], v[192:195], v[116:119]
    v_mfma_f32_16x16x32_bf16 v[120:123], v[24:27], v[196:199], v[120:123]
    v_mfma_f32_32x32x16_bf16 v[64:79], v[40:43], v[32:35], v[64:79]
    ds_read_b128 v[184:187], v16 offset:8192
    ds_read_b64_tr_b16 v[188:189], v20 offset:24576
    ds_read_b64_tr_b16 v[190:191], v20 offset:25088
    v_mfma_f32_32x32x16_bf16 v[80:95], v[44:47], v[32:35], v[80:95]
    ds_read_b64_tr_b16 v[192:193], v20 offset:25600
    ds_read_b64_tr_b16 v[194:195], v20 offset:26112
    ds_read_b64_tr_b16 v[196:197], v20 offset:26624
    v_mfma_f32_32x32x16_bf16 v[96:111], v[32:35], v[48:51], v[96:111]
    ds_read_b64_tr_b16 v[198:199], v20 offset:27136
    s_waitcnt lgkmcnt(11)
    v_mfma_f32_32x32x16_bf16 v[64:79], v[52:55], v[36:39], v[64:79]
    ds_read_b128 v[32:35], v17 offset:8192
    ds_read_b64_tr_b16 v[40:41], v19 offset:36864
    ds_read_b64_tr_b16 v[42:43], v19 offset:37376
    s_waitcnt lgkmcnt(12)
    v_mfma_f32_32x32x16_bf16 v[80:95], v[56:59], v[36:39], v[80:95]
    ds_read_b64_tr_b16 v[44:45], v19 offset:37888
    ds_read_b64_tr_b16 v[46:47], v19 offset:38400
    ds_read_b64_tr_b16 v[48:49], v19 offset:38912
    s_waitcnt lgkmcnt(13)
    v_mfma_f32_32x32x16_bf16 v[96:111], v[36:39], v[60:63], v[96:111]
    ds_read_b64_tr_b16 v[50:51], v19 offset:39424
    v_mfma_f32_16x16x32_bf16 v[112:115], v[24:27], v[52:55], v[112:115]
    v_mfma_f32_16x16x32_bf16 v[116:119], v[24:27], v[56:59], v[116:119]
    v_mfma_f32_16x16x32_bf16 v[120:123], v[24:27], v[60:63], v[120:123]
    s_waitcnt lgkmcnt(11)
    v_mfma_f32_32x32x16_bf16 v[64:79], v[188:191], v[184:187], v[64:79]
    ds_read_b128 v[36:39], v18 offset:8192
    ds_read_b64_tr_b16 v[52:53], v20 offset:36864
    ds_read_b64_tr_b16 v[54:55], v20 offset:37376
    s_waitcnt lgkmcnt(12)
    v_mfma_f32_32x32x16_bf16 v[80:95], v[192:195], v[184:187], v[80:95]
    ds_read_b64_tr_b16 v[56:57], v20 offset:37888
    ds_read_b64_tr_b16 v[58:59], v20 offset:38400
    ds_read_b64_tr_b16 v[60:61], v20 offset:38912
    s_waitcnt lgkmcnt(13)
    v_mfma_f32_32x32x16_bf16 v[96:111], v[184:187], v[196:199], v[96:111]
    ds_read_b64_tr_b16 v[62:63], v20 offset:39424
    s_waitcnt lgkmcnt(11)
    v_mfma_f32_32x32x16_bf16 v[64:79], v[40:43], v[32:35], v[64:79]
    s_waitcnt lgkmcnt(0)
    s_cmp_lg_u32 s40, 4
    s_cbranch_scc1 L_p1_w0
    s_waitcnt vmcnt(1)
    s_branch L_p1_w1
L_p1_w0:
    s_waitcnt vmcnt(0)
L_p1_w1:
    s_barrier
    ds_read_b128 v[184:187], v15 offset:16384
    ds_read_b64_tr_b16 v[188:189], v22 offset:0
    ds_read_b64_tr_b16 v[190:191], v22 offset:512
    v_mfma_f32_32x32x16_bf16 v[80:95], v[44:47], v[32:35], v[80:95]
    ds_read_b64_tr_b16 v[192:193], v22 offset:1024
    ds_read_b64_tr_b16 v[194:195], v22 offset:1536
    ds_read_b64_tr_b16 v[196:197], v22 offset:2048
    v_mfma_f32_32x32x16_bf16 v[96:111], v[32:35], v[48:51], v[96:111]
    ds_read_b64_tr_b16 v[198:199], v22 offset:2560
    v_mfma_f32_16x16x32_bf16 v[112:115], v[24:27], v[40:43], v[112:115]
    v_mfma_f32_16x16x32_bf16 v[116:119], v[24:27], v[44:47], v[116:119]
    v_mfma_f32_16x16x32_bf16 v[120:123], v[24:27], v[48:51], v[120:123]
    v_mfma_f32_32x32x16_bf16 v[64:79], v[52:55], v[36:39], v[64:79]
    ds_read_b128 v[32:35], v16 offset:16384
    ds_read_b64_tr_b16 v[40:41], v23 offset:0
    ds_read_b64_tr_b16 v[42:43], v23 offset:512
    v_mfma_f32_32x32x16_bf16 v[80:95], v[56:59], v[36:39], v[80:95]
    ds_read_b64_tr_b16 v[44:45], v23 offset:1024
    ds_read_b64_tr_b16 v[46:47], v23 offset:1536
    ds_read_b64_tr_b16 v[48:49], v23 offset:2048
    v_mfma_f32_32x32x16_bf16 v[96:111], v[36:39], v[60:63], v[96:111]
    ds_read_b64_tr_b16 v[50:51], v23 offset:2560
    s_waitcnt lgkmcnt(11)
    v_mfma_f32_32x32x16_bf16 v[64:79], v[188:191], v[184:187], v[64:79]
    ds_read_b128 v[36:39], v17 offset:16384
    ds_read_b64_tr_b16 v[52:53], v22 offset:12288
    ds_read_b64_tr_b16 v[54:55], v22 offset:12800
    s_waitcnt lgkmcnt(12)
    v_mfma_f32_32x32x16_bf16 v[80:95], v[192:195], v[184:187], v[80:95]
    ds_read_b64_tr_b16 v[56:57], v22 offset:13312
    ds_read_b64_tr_b16 v[58:59], v22 offset:13824
    ds_read_b64_tr_b16 v[60:61], v22 offset:14336
    s_waitcnt lgkmcnt(13)
    v_mfma_f32_32x32x16_bf16 v[96:111], v[184:187], v[196:199], v[96:111]
    ds_read_b64_tr_b16 v[62:63], v22 offset:14848
    v_mfma_f32_16x16x32_bf16 v[112:115], v[24:27], v[188:191], v[112:115]
    v_mfma_f32_16x16x32_bf16 v[116:119], v[24:27], v[192:195], v[116:119]
    v_mfma_f32_16x16x32_bf16 v[120:123], v[24:27], v[196:199], v[120:123]
    s_waitcnt lgkmcnt(11)
    v_mfma_f32_32x32x16_bf16 v[64:79], v[40:43], v[32:35], v[64:79]
    ds_read_b128 v[184:187], v18 offset:16384
    ds_read_b64_tr_b16 v[188:189], v23 offset:12288
    ds_read_b64_tr_b16 v[190:191], v23 offset:12800
    s_waitcnt lgkmcnt(12)
    v_mfma_f32_32x32x16_bf16 v[80:95], v[44:47], v[32:35], v[80:95]
    ds_read_b64_tr_b16 v[192:193], v23 offset:13312
    ds_read_b64_tr_b16 v[194:195], v23 offset:13824
    ds_read_b64_tr_b16 v[196:197], v23 offset:14336
    s_waitcnt lgkmcnt(13)
    v_mfma_f32_32x32x16_bf16 v[96:111], v[32:35], v[48:51], v[96:111]
    ds_read_b64_tr_b16 v[198:199], v23 offset:14848
    s_waitcnt lgkmcnt(11)
    v_mfma_f32_32x32x16_bf16 v[64:79], v[52:55], v[36:39], v[64:79]
    s_waitcnt lgkmcnt(0)
    s_barrier
    ds_read_b128 v[32:35], v15 offset:24576
    ds_read_b64_tr_b16 v[40:41], v19 offset:0
    ds_read_b64_tr_b16 v[42:43], v19 offset:512
    v_mfma_f32_32x32x16_bf16 v[80:95], v[56:59], v[36:39], v[80:95]
    ds_read_b64_tr_b16 v[44:45], v19 offset:1024
    ds_read_b64_tr_b16 v[46:47], v19 offset:1536
    ds_read_b64_tr_b16 v[48:49], v19 offset:2048
    v_mfma_f32_32x32x16_bf16 v[96:111], v[36:39], v[60:63], v[96:111]
    ds_read_b64_tr_b16 v[50:51], v19 offset:2560
    v_mfma_f32_16x16x32_bf16 v[112:115], v[24:27], v[52:55], v[112:115]
    v_mfma_f32_16x16x32_bf16 v[116:119], v[24:27], v[56:59], v[116:119]
    v_mfma_f32_16x16x32_bf16 v[120:123], v[24:27], v[60:63], v[120:123]
    s_cmp_lg_u32 s40, 4
    s_cbranch_scc1 L_p1_np
    s_lshl_b32 s45, s18, 5
    s_add_u32 s45, s45, s19
    v_mov_b32 v4, 0
    v_mov_b32 v5, s62
    s_mov_b64 exec, 1
    s_waitcnt vmcnt(0)
    buffer_store_byte v5, v4, s[96:99], s45 offen sc1
    s_mov_b64 exec, -1
L_p1_np:
    v_mfma_f32_32x32x16_bf16 v[64:79], v[188:191], v[184:187], v[64:79]
    ds_read_b128 v[36:39], v16 offset:24576
    ds_read_b64_tr_b16 v[52:53], v20 offset:0
    ds_read_b64_tr_b16 v[54:55], v20 offset:512
    v_mfma_f32_32x32x16_bf16 v[80:95], v[192:195], v[184:187], v[80:95]
    ds_read_b64_tr_b16 v[56:57], v20 offset:1024
    ds_read_b64_tr_b16 v[58:59], v20 offset:1536
    ds_read_b64_tr_b16 v[60:61], v20 offset:2048
    v_mfma_f32_32x32x16_bf16 v[96:111], v[184:187], v[196:199], v[96:111]
    ds_read_b64_tr_b16 v[62:63], v20 offset:2560
    s_waitcnt lgkmcnt(11)
    v_mfma_f32_32x32x16_bf16 v[64:79], v[40:43], v[32:35], v[64:79]
    ds_read_b128 v[184:187], v17 offset:24576
    ds_read_b64_tr_b16 v[188:189], v19 offset:12288
    ds_read_b64_tr_b16 v[190:191], v19 offset:12800
    s_waitcnt lgkmcnt(12)
    v_mfma_f32_32x32x16_bf16 v[80:95], v[44:47], v[32:35], v[80:95]
    ds_read_b64_tr_b16 v[192:193], v19 offset:13312
    ds_read_b64_tr_b16 v[194:195], v19 offset:13824
    ds_read_b64_tr_b16 v[196:197], v19 offset:14336
    s_waitcnt lgkmcnt(13)
    v_mfma_f32_32x32x16_bf16 v[96:111], v[32:35], v[48:51], v[96:111]
    ds_read_b64_tr_b16 v[198:199], v19 offset:14848
    v_mfma_f32_16x16x32_bf16 v[112:115], v[24:27], v[40:43], v[112:115]
    v_mfma_f32_16x16x32_bf16 v[116:119], v[24:27], v[44:47], v[116:119]
    v_mfma_f32_16x16x32_bf16 v[120:123], v[24:27], v[48:51], v[120:123]
    s_waitcnt lgkmcnt(11)
    v_mfma_f32_32x32x16_bf16 v[64:79], v[52:55], v[36:39], v[64:79]
    ds_read_b128 v[32:35], v18 offset:24576
    ds_read_b64_tr_b16 v[40:41], v20 offset:12288
    ds_read_b64_tr_b16 v[42:43], v20 offset:12800
    s_waitcnt lgkmcnt(12)
    v_mfma_f32_32x32x16_bf16 v[80:95], v[56:59], v[36:39], v[80:95]
    ds_read_b64_tr_b16 v[44:45], v20 offset:13312
    ds_read_b64_tr_b16 v[46:47], v20 offset:13824
    ds_read_b64_tr_b16 v[48:49], v20 offset:14336
    s_waitcnt lgkmcnt(13)
    v_mfma_f32_32x32x16_bf16 v[96:111], v[36:39], v[60:63], v[96:111]
    ds_read_b64_tr_b16 v[50:51], v20 offset:14848
    s_waitcnt lgkmcnt(11)
    v_mfma_f32_32x32x16_bf16 v[64:79], v[188:191], v[184:187], v[64:79]
    s_waitcnt lgkmcnt(0)
    s_barrier
    ds_read_b128 v[36:39], v15 offset:32768
    ds_read_b64_tr_b16 v[52:53], v19 offset:24576
    ds_read_b64_tr_b16 v[54:55], v19 offset:25088
    v_mfma_f32_32x32x16_bf16 v[80:95], v[192:195], v[184:187], v[80:95]
    ds_read_b64_tr_b16 v[56:57], v19 offset:25600
    ds_read_b64_tr_b16 v[58:59], v19 offset:26112
    ds_read_b64_tr_b16 v[60:61], v19 offset:26624
    v_mfma_f32_32x32x16_bf16 v[96:111], v[184:187], v[196:199], v[96:111]
    ds_read_b64_tr_b16 v[62:63], v19 offset:27136
    v_mfma_f32_16x16x32_bf16 v[112:115], v[24:27], v[188:191], v[112:115]
    v_mfma_f32_16x16x32_bf16 v[116:119], v[24:27], v[192:195], v[116:119]
    v_mfma_f32_16x16x32_bf16 v[120:123], v[24:27], v[196:199], v[120:123]
    v_mfma_f32_32x32x16_bf16 v[64:79], v[40:43], v[32:35], v[64:79]
    ds_read_b128 v[184:187], v16 offset:32768
    ds_read_b64_tr_b16 v[188:189], v20 offset:24576
    ds_read_b64_tr_b16 v[190:191], v20 offset:25088
    v_mfma_f32_32x32x16_bf16 v[80:95], v[44:47], v[32:35], v[80:95]
    ds_read_b64_tr_b16 v[192:193], v20 offset:25600
    ds_read_b64_tr_b16 v[194:195], v20 offset:26112
    ds_read_b64_tr_b16 v[196:197], v20 offset:26624
    v_mfma_f32_32x32x16_bf16 v[96:111], v[32:35], v[48:51], v[96:111]
    ds_read_b64_tr_b16 v[198:199], v20 offset:27136
    s_waitcnt lgkmcnt(11)
    v_mfma_f32_32x32x16_bf16 v[64:79], v[52:55], v[36:39], v[64:79]
    ds_read_b128 v[32:35], v17 offset:32768
    ds_read_b64_tr_b16 v[40:41], v19 offset:36864
    ds_read_b64_tr_b16 v[42:43], v19 offset:37376
    s_waitcnt lgkmcnt(12)
    v_mfma_f32_32x32x16_bf16 v[80:95], v[56:59], v[36:39], v[80:95]
    ds_read_b64_tr_b16 v[44:45], v19 offset:37888
    ds_read_b64_tr_b16 v[46:47], v19 offset:38400
    ds_read_b64_tr_b16 v[48:49], v19 offset:38912
    s_waitcnt lgkmcnt(13)
    v_mfma_f32_32x32x16_bf16 v[96:111], v[36:39], v[60:63], v[96:111]
    ds_read_b64_tr_b16 v[50:51], v19 offset:39424
    v_mfma_f32_16x16x32_bf16 v[112:115], v[24:27], v[52:55], v[112:115]
    v_mfma_f32_16x16x32_bf16 v[116:119], v[24:27], v[56:59], v[116:119]
    v_mfma_f32_16x16x32_bf16 v[120:123], v[24:27], v[60:63], v[120:123]
    s_waitcnt lgkmcnt(11)
    v_mfma_f32_32x32x16_bf16 v[64:79], v[188:191], v[184:187], v[64:79]
    ds_read_b128 v[36:39], v18 offset:32768
    ds_read_b64_tr_b16 v[52:53], v20 offset:36864
    ds_read_b64_tr_b16 v[54:55], v20 offset:37376
    s_waitcnt lgkmcnt(12)
    v_mfma_f32_32x32x16_bf16 v[80:95], v[192:195], v[184:187], v[80:95]
    ds_read_b64_tr_b16 v[56:57], v20 offset:37888
    ds_read_b64_tr_b16 v[58:59], v20 offset:38400
    ds_read_b64_tr_b16 v[60:61], v20 offset:38912
    s_waitcnt lgkmcnt(13)
    v_mfma_f32_32x32x16_bf16 v[96:111], v[184:187], v[196:199], v[96:111]
    ds_read_b64_tr_b16 v[62:63], v20 offset:39424
    s_waitcnt lgkmcnt(11)
    v_mfma_f32_32x32x16_bf16 v[64:79], v[40:43], v[32:35], v[64:79]
    s_waitcnt lgkmcnt(0)
    s_barrier
    ds_read_b128 v[184:187], v15 offset:40960
    ds_read_b64_tr_b16 v[188:189], v22 offset:0
    ds_read_b64_tr_b16 v[190:191], v22 offset:512
    v_mfma_f32_32x32x16_bf16 v[80:95], v[44:47], v[32:35], v[80:95]
    ds_read_b64_tr_b16 v[192:193], v22 offset:1024
    ds_read_b64_tr_b16 v[194:195], v22 offset:1536
    ds_read_b64_tr_b16 v[196:197], v22 offset:2048
    v_mfma_f32_32x32x16_bf16 v[96:111], v[32:35], v[48:51], v[96:111]
    ds_read_b64_tr_b16 v[198:199], v22 offset:2560
    v_mfma_f32_16x16x32_bf16 v[112:115], v[24:27], v[40:43], v[112:115]
    v_mfma_f32_16x16x32_bf16 v[116:119], v[24:27], v[44:47], v[116:119]
    v_mfma_f32_16x16x32_bf16 v[120:123], v[24:27], v[48:51], v[120:123]
    v_mfma_f32_32x32x16_bf16 v[64:79], v[52:55], v[36:39], v[64:79]
    ds_read_b128 v[32:35], v16 offset:40960
    ds_read_b64_tr_b16 v[40:41], v23 offset:0
    ds_read_b64_tr_b16 v[42:43], v23 offset:512
    v_mfma_f32_32x32x16_bf16 v[80:95], v[56:59], v[36:39], v[80:95]
    ds_read_b64_tr_b16 v[44:45], v23 offset:1024
    ds_read_b64_tr_b16 v[46:47], v23 offset:1536
    ds_read_b64_tr_b16 v[48:49], v23 offset:2048
    v_mfma_f32_32x32x16_bf16 v[96:111], v[36:39], v[60:63], v[96:111]
    ds_read_b64_tr_b16 v[50:51], v23 offset:2560
    s_waitcnt lgkmcnt(11)
    v_mfma_f32_32x32x16_bf16 v[64:79], v[188:191], v[184:187], v[64:79]
    ds_read_b128 v[36:39], v17 offset:40960
    ds_read_b64_tr_b16 v[52:53], v22 offset:12288
    ds_read_b64_tr_b16 v[54:55], v22 offset:12800
    s_waitcnt lgkmcnt(12)
    v_mfma_f32_32x32x16_bf16 v[80:95], v[192:195], v[184:187], v[80:95]
    ds_read_b64_tr_b16 v[56:57], v22 offset:13312
    ds_read_b64_tr_b16 v[58:59], v22 offset:13824
    ds_read_b64_tr_b16 v[60:61], v22 offset:14336
    s_waitcnt lgkmcnt(13)
    v_mfma_f32_32x32x16_bf16 v[96:111], v[184:187], v[196:199], v[96:111]
    ds_read_b64_tr_b16 v[62:63], v22 offset:14848
    v_mfma_f32_16x16x32_bf16 v[112:115], v[24:27], v[188:191], v[112:115]
    v_mfma_f32_16x16x32_bf16 v[116:119], v[24:27], v[192:195], v[116:119]
    v_mfma_f32_16x16x32_bf16 v[120:123], v[24:27], v[196:199], v[120:123]
    s_waitcnt lgkmcnt(11)
    v_mfma_f32_32x32x16_bf16 v[64:79], v[40:43], v[32:35], v[64:79]
    ds_read_b128 v[184:187], v18 offset:40960
    ds_read_b64_tr_b16 v[188:189], v23 offset:12288
    ds_read_b64_tr_b16 v[190:191], v23 offset:12800
    s_waitcnt lgkmcnt(12)
    v_mfma_f32_32x32x16_bf16 v[80:95], v[44:47], v[32:35], v[80:95]
    ds_read_b64_tr_b16 v[192:193], v23 offset:13312
    ds_read_b64_tr_b16 v[194:195], v23 offset:13824
    ds_read_b64_tr_b16 v[196:197], v23 offset:14336
    s_waitcnt lgkmcnt(13)
    v_mfma_f32_32x32x16_bf16 v[96:111], v[32:35], v[48:51], v[96:111]
    ds_read_b64_tr_b16 v[198:199], v23 offset:14848
    s_waitcnt lgkmcnt(11)
    v_mfma_f32_32x32x16_bf16 v[64:79], v[52:55], v[36:39], v[64:79]
    s_waitcnt lgkmcnt(0)
    s_barrier
    ds_read_b128 v[32:35], v15 offset:49152
    ds_read_b64_tr_b16 v[40:41], v19 offset:0
    ds_read_b64_tr_b16 v[42:43], v19 offset:512
    v_mfma_f32_32x32x16_bf16 v[80:95], v[56:59], v[36:39], v[80:95]
    ds_read_b64_tr_b16 v[44:45], v19 offset:1024
    ds_read_b64_tr_b16 v[46:47], v19 offset:1536
    ds_read_b64_tr_b16 v[48:49], v19 offset:2048
    v_mfma_f32_32x32x16_bf16 v[96:111], v[36:39], v[60:63], v[96:111]
    ds_read_b64_tr_b16 v[50:51], v19 offset:2560
    v_mfma_f32_16x16x32_bf16 v[112:115], v[24:27], v[52:55], v[112:115]
    v_mfma_f32_16x16x32_bf16 v[116:119], v[24:27], v[56:59], v[116:119]
    v_mfma_f32_16x16x32_bf16 v[120:123], v[24:27], v[60:63], v[120:123]
    v_mfma_f32_32x32x16_bf16 v[64:79], v[188:191], v[184:187], v[64:79]
    ds_read_b128 v[36:39], v16 offset:49152
    ds_read_b64_tr_b16 v[52:53], v20 offset:0
    ds_read_b64_tr_b16 v[54:55], v20 offset:512
    v_mfma_f32_32x32x16_bf16 v[80:95], v[192:195], v[184:187], v[80:95]
    ds_read_b64_tr_b16 v[56:57], v20 offset:1024
    ds_read_b64_tr_b16 v[58:59], v20 offset:1536
    ds_read_b64_tr_b16 v[60:61], v20 offset:2048
    v_mfma_f32_32x32x16_bf16 v[96:111], v[184:187], v[196:199], v[96:111]
    ds_read_b64_tr_b16 v[62:63], v20 offset:2560
    s_waitcnt lgkmcnt(11)
    v_mfma_f32_32x32x16_bf16 v[64:79], v[40:43], v[32:35], v[64:79]
    ds_read_b128 v[184:187], v17 offset:49152
    ds_read_b64_tr_b16 v[188:189], v19 offset:12288
    ds_read_b64_tr_b16 v[190:191], v19 offset:12800
    s_waitcnt lgkmcnt(12)
    v_mfma_f32_32x32x16_bf16 v[80:95], v[44:47], v[32:35], v[80:95]
    ds_read_b64_tr_b16 v[192:193], v19 offset:13312
    ds_read_b64_tr_b16 v[194:195], v19 offset:13824
    ds_read_b64_tr_b16 v[196:197], v19 offset:14336
    s_waitcnt lgkmcnt(13)
    v_mfma_f32_32x32x16_bf16 v[96:111], v[32:35], v[48:51], v[96:111]
    ds_read_b64_tr_b16 v[198:199], v19 offset:14848
    v_mfma_f32_16x16x32_bf16 v[112:115], v[24:27], v[40:43], v[112:115]
    v_mfma_f32_16x16x32_bf16 v[116:119], v[24:27], v[44:47], v[116:119]
    v_mfma_f32_16x16x32_bf16 v[120:123], v[24:27], v[48:51], v[120:123]
    s_waitcnt lgkmcnt(11)
    v_mfma_f32_32x32x16_bf16 v[64:79], v[52:55], v[36:39], v[64:79]
    ds_read_b128 v[32:35], v18 offset:49152
    ds_read_b64_tr_b16 v[40:41], v20 offset:12288
    ds_read_b64_tr_b16 v[42:43], v20 offset:12800
    s_waitcnt lgkmcnt(12)
    v_mfma_f32_32x32x16_bf16 v[80:95], v[56:59], v[36:39], v[80:95]
    ds_read_b64_tr_b16 v[44:45], v20 offset:13312
    ds_read_b64_tr_b16 v[46:47], v20 offset:13824
    ds_read_b64_tr_b16 v[48:49], v20 offset:14336
    s_waitcnt lgkmcnt(13)
    v_mfma_f32_32x32x16_bf16 v[96:111], v[36:39], v[60:63], v[96:111]
    ds_read_b64_tr_b16 v[50:51], v20 offset:14848
    s_waitcnt lgkmcnt(11)
    v_mfma_f32_32x32x16_bf16 v[64:79], v[188:191], v[184:187], v[64:79]
    s_waitcnt lgkmcnt(0)
    s_barrier
    ds_read_b128 v[36:39], v15 offset:57344
    ds_read_b64_tr_b16 v[52:53], v19 offset:24576
    ds_read_b64_tr_b16 v[54:55], v19 offset:25088
    v_mfma_f32_32x32x16_bf16 v[80:95], v[192:195], v[184:187], v[80:95]
    ds_read_b64_tr_b16 v[56:57], v19 offset:25600
    ds_read_b64_tr_b16 v[58:59], v19 offset:26112
    ds_read_b64_tr_b16 v[60:61], v19 offset:26624
    v_mfma_f32_32x32x16_bf16 v[96:111], v[184:187], v[196:199], v[96:111]
    ds_read_b64_tr_b16 v[62:63], v19 offset:27136
    v_mfma_f32_16x16x32_bf16 v[112:115], v[24:27], v[188:191], v[112:115]
    v_mfma_f32_16x16x32_bf16 v[116:119], v[24:27], v[192:195], v[116:119]
    v_mfma_f32_16x16x32_bf16 v[120:123], v[24:27], v[196:199], v[120:123]
    v_mfma_f32_32x32x16_bf16 v[64:79], v[40:43], v[32:35], v[64:79]
    ds_read_b128 v[184:187], v16 offset:57344
    ds_read_b64_tr_b16 v[188:189], v20 offset:24576
    ds_read_b64_tr_b16 v[190:191], v20 offset:25088
    v_mfma_f32_32x32x16_bf16 v[80:95], v[44:47], v[32:35], v[80:95]
    ds_read_b64_tr_b16 v[192:193], v20 offset:25600
    ds_read_b64_tr_b16 v[194:195], v20 offset:26112
    ds_read_b64_tr_b16 v[196:197], v20 offset:26624
    v_mfma_f32_32x32x16_bf16 v[96:111], v[32:35], v[48:51], v[96:111]
    ds_read_b64_tr_b16 v[198:199], v20 offset:27136
    s_waitcnt lgkmcnt(11)
    v_mfma_f32_32x32x16_bf16 v[64:79], v[52:55], v[36:39], v[64:79]
    ds_read_b128 v[32:35], v17 offset:57344
    ds_read_b64_tr_b16 v[40:41], v19 offset:36864
    ds_read_b64_tr_b16 v[42:43], v19 offset:37376
    ds_read_b64_tr_b16 v[44:45], v19 offset:37888
    s_waitcnt lgkmcnt(13)
    v_mfma_f32_32x32x16_bf16 v[80:95], v[56:59], v[36:39], v[80:95]
    ds_read_b64_tr_b16 v[46:47], v19 offset:38400
    ds_read_b64_tr_b16 v[48:49], v19 offset:38912
    ds_read_b64_tr_b16 v[50:51], v19 offset:39424
    s_waitcnt lgkmcnt(14)
    v_mfma_f32_32x32x16_bf16 v[96:111], v[36:39], v[60:63], v[96:111]
    s_lshl_b32 s38, s18, 5
    buffer_load_dword v230, v229, s[96:99], s38 offen sc1
    v_mfma_f32_16x16x32_bf16 v[112:115], v[24:27], v[52:55], v[112:115]
    v_mfma_f32_16x16x32_bf16 v[116:119], v[24:27], v[56:59], v[116:119]
    v_mfma_f32_16x16x32_bf16 v[120:123], v[24:27], v[60:63], v[120:123]
    s_waitcnt lgkmcnt(11)
    v_mfma_f32_32x32x16_bf16 v[64:79], v[188:191], v[184:187], v[64:79]
    ds_read_b128 v[36:39], v18 offset:57344
    ds_read_b64_tr_b16 v[52:53], v20 offset:36864
    ds_read_b64_tr_b16 v[54:55], v20 offset:37376
    s_waitcnt lgkmcnt(12)
    v_mfma_f32_32x32x16_bf16 v[80:95], v[192:195], v[184:187], v[80:95]
    ds_read_b64_tr_b16 v[56:57], v20 offset:37888
    ds_read_b64_tr_b16 v[58:59], v20 offset:38400
    ds_read_b64_tr_b16 v[60:61], v20 offset:38912
    s_waitcnt lgkmcnt(13)
    v_mfma_f32_32x32x16_bf16 v[96:111], v[184:187], v[196:199], v[96:111]
    ds_read_b64_tr_b16 v[62:63], v20 offset:39424
    s_waitcnt lgkmcnt(11)
    v_mfma_f32_32x32x16_bf16 v[64:79], v[40:43], v[32:35], v[64:79]
    s_barrier
    s_waitcnt lgkmcnt(9)
    v_mfma_f32_32x32x16_bf16 v[80:95], v[44:47], v[32:35], v[80:95]
    s_waitcnt lgkmcnt(7)
    v_mfma_f32_32x32x16_bf16 v[96:111], v[32:35], v[48:51], v[96:111]
    v_mfma_f32_16x16x32_bf16 v[112:115], v[24:27], v[40:43], v[112:115]
    v_mfma_f32_16x16x32_bf16 v[116:119], v[24:27], v[44:47], v[116:119]
    v_mfma_f32_16x16x32_bf16 v[120:123], v[24:27], v[48:51], v[120:123]
    s_waitcnt lgkmcnt(4)
    v_mfma_f32_32x32x16_bf16 v[64:79], v[52:55], v[36:39], v[64:79]
    s_waitcnt lgkmcnt(2)
    v_mfma_f32_32x32x16_bf16 v[80:95], v[56:59], v[36:39], v[80:95]
    s_waitcnt lgkmcnt(0)
    v_mfma_f32_32x32x16_bf16 v[96:111], v[36:39], v[60:63], v[96:111]
    s_nop 3
    ds_write_b32 v10, v112 offset:0
    ds_write_b32 v10, v116 offset:128
    ds_write_b32 v10, v120 offset:256
    s_waitcnt lgkmcnt(0)
    s_barrier
    ds_read_b32 v140, v11 offset:0
    ds_read_b32 v141, v11 offset:128
    ds_read_b32 v142, v11 offset:256
    ds_read_b64 v[124:125], v14
    ds_read_b32 v146, v12
    ds_read_b128 v[148:151], v13 offset:0
    ds_read_b128 v[152:155], v13 offset:32
    ds_read_b128 v[156:159], v13 offset:64
    ds_read_b128 v[160:163], v13 offset:96
    s_waitcnt lgkmcnt(8)
    v_cvt_pk_bf16_f32 v7, v140, v140
    v_and_b32 v7, s44, v7
    v_sub_f32 v7, v140, v7
    v_cvt_pk_bf16_f32 v128, v140, v7
    v_mov_b32 v129, v128
    v_mov_b32 v130, 0
    v_mov_b32 v131, 0
    s_waitcnt lgkmcnt(7)
    v_cvt_pk_bf16_f32 v7, v141, v141
    v_and_b32 v7, s44, v7
    v_sub_f32 v7, v141, v7
    v_cvt_pk_bf16_f32 v132, v141, v7
    v_mov_b32 v133, v132
    v_mov_b32 v134, 0
    v_mov_b32 v135, 0
    s_waitcnt lgkmcnt(6)
    v_cvt_pk_bf16_f32 v7, v142, v142
    v_and_b32 v7, s44, v7
    v_sub_f32 v7, v142, v7
    v_cvt_pk_bf16_f32 v136, v142, v7
    v_mov_b32 v137, v136
    v_mov_b32 v138, 0
    v_mov_b32 v139, 0
    s_waitcnt lgkmcnt(4)
    v_mul_f32 v147, 0x3eb8aa3b, v146
    v_mfma_f32_32x32x16_bf16 v[64:79], v[128:131], v[124:127], v[64:79]
    v_mfma_f32_32x32x16_bf16 v[80:95], v[132:135], v[124:127], v[80:95]
    v_mfma_f32_32x32x16_bf16 v[96:111], v[124:127], v[136:139], v[96:111]
    s_lshl_b32 s38, s18, 5
    s_mov_b32 s36, 0
    s_branch L_tc_c_w
L_tc_c:
    buffer_load_dword v230, v229, s[96:99], s38 offen sc1
L_tc_c_w:
    s_add_u32 s36, s36, 1
    s_waitcnt vmcnt(0)
    v_subrev_u32 v231, 0x01010101, v230
    v_not_b32 v232, v230
    v_and_b32 v231, v231, v232
    v_and_b32 v231, 0x80808080, v231
    v_cmp_eq_u32 vcc, 0, v231
    s_cmp_gt_u32 s36, 0x40000
    s_cbranch_scc1 L_tc_c_d
    s_and_b32 s37, vcc_lo, 0xff
    s_cmp_lg_u32 s37, 0xff
    s_cbranch_scc1 L_tc_c
L_tc_c_d:
    s_mul_i32 s37, s62, 0x01010101
    v_cmp_eq_u32 vcc, s37, v230
    s_nop 3
    s_or_b32 s63, vcc_lo, 0xffffff00
    v_mul_f32 v80, v146, v80
    v_mul_f32 v81, v146, v81
    v_mul_f32 v82, v146, v82
    v_mul_f32 v83, v146, v83
    v_mul_f32 v84, v146, v84
    v_mul_f32 v85, v146, v85
    v_mul_f32 v86, v146, v86
    v_mul_f32 v87, v146, v87
    v_cvt_pk_bf16_f32 v32, v80, v81
    v_cvt_pk_bf16_f32 v33, v82, v83
    v_cvt_pk_bf16_f32 v34, v84, v85
    v_cvt_pk_bf16_f32 v35, v86, v87
    v_mul_f32 v88, v146, v88
    v_mul_f32 v89, v146, v89
    v_mul_f32 v90, v146, v90
    v_mul_f32 v91, v146, v91
    v_mul_f32 v92, v146, v92
    v_mul_f32 v93, v146, v93
    v_mul_f32 v94, v146, v94
    v_mul_f32 v95, v146, v95
    v_cvt_pk_bf16_f32 v36, v88, v89
    v_cvt_pk_bf16_f32 v37, v90, v91
    v_cvt_pk_bf16_f32 v38, v92, v93
    v_cvt_pk_bf16_f32 v39, v94, v95
    s_cmp_eq_u32 s63, -1
    s_cbranch_scc1 L_hs_p11_f
    buffer_store_dwordx4 v[32:35], v2, s[20:23], s59 offen sc1
    buffer_store_dwordx4 v[36:39], v2, s[20:23], s60 offen sc1
    s_branch L_hs_p11_d
L_hs_p11_f:
    buffer_store_dwordx4 v[32:35], v2, s[20:23], s59 offen
    buffer_store_dwordx4 v[36:39], v2, s[20:23], s60 offen
L_hs_p11_d:
    v_mul_f32 v64, v147, v64
    v_mul_f32 v65, v147, v65
    v_mul_f32 v66, v147, v66
    v_mul_f32 v67, v147, v67
    v_mul_f32 v68, v147, v68
    v_mul_f32 v69, v147, v69
    v_mul_f32 v70, v147, v70
    v_mul_f32 v71, v147, v71
    v_cvt_pk_bf16_f32 v40, v64, v65
    v_cvt_pk_bf16_f32 v41, v66, v67
    v_cvt_pk_bf16_f32 v42, v68, v69
    v_cvt_pk_bf16_f32 v43, v70, v71
    v_mul_f32 v72, v147, v72
    v_mul_f32 v73, v147, v73
    v_mul_f32 v74, v147, v74
    v_mul_f32 v75, v147, v75
    v_mul_f32 v76, v147, v76
    v_mul_f32 v77, v147, v77
    v_mul_f32 v78, v147, v78
    v_mul_f32 v79, v147, v79
    v_cvt_pk_bf16_f32 v44, v72, v73
    v_cvt_pk_bf16_f32 v45, v74, v75
    v_cvt_pk_bf16_f32 v46, v76, v77
    v_cvt_pk_bf16_f32 v47, v78, v79
    s_cmp_eq_u32 s63, -1
    s_cbranch_scc1 L_hs_p10_f
    buffer_store_dwordx4 v[40:43], v2, s[20:23], s57 offen sc1
    buffer_store_dwordx4 v[44:47], v2, s[20:23], s58 offen sc1
    s_branch L_hs_p10_d
L_hs_p10_f:
    buffer_store_dwordx4 v[40:43], v2, s[20:23], s57 offen
    buffer_store_dwordx4 v[44:47], v2, s[20:23], s58 offen
L_hs_p10_d:
    s_waitcnt lgkmcnt(0)
    v_mul_f32 v96, v148, v96
    v_mul_f32 v97, v149, v97
    v_mul_f32 v98, v150, v98
    v_mul_f32 v99, v151, v99
    v_mul_f32 v100, v152, v100
    v_mul_f32 v101, v153, v101
    v_mul_f32 v102, v154, v102
    v_mul_f32 v103, v155, v103
    v_cvt_pk_bf16_f32 v48, v96, v97
    v_cvt_pk_bf16_f32 v49, v98, v99
    v_cvt_pk_bf16_f32 v50, v100, v101
    v_cvt_pk_bf16_f32 v51, v102, v103
    v_mul_f32 v104, v156, v104
    v_mul_f32 v105, v157, v105
    v_mul_f32 v106, v158, v106
    v_mul_f32 v107, v159, v107
    v_mul_f32 v108, v160, v108
    v_mul_f32 v109, v161, v109
    v_mul_f32 v110, v162, v110
    v_mul_f32 v111, v163, v111
    v_cvt_pk_bf16_f32 v52, v104, v105
    v_cvt_pk_bf16_f32 v53, v106, v107
    v_cvt_pk_bf16_f32 v54, v108, v109
    v_cvt_pk_bf16_f32 v55, v110, v111
    s_cmp_eq_u32 s63, -1
    s_cbranch_scc1 L_hs_p1v_f
    buffer_store_dwordx4 v[48:51], v21, s[20:23], s61 offen offset:0 sc1
    buffer_store_dwordx4 v[52:55], v21, s[20:23], s61 offen offset:512 sc1
    s_branch L_hs_p1v_d
L_hs_p1v_f:
    buffer_store_dwordx4 v[48:51], v21, s[20:23], s61 offen offset:0
    buffer_store_dwordx4 v[52:55], v21, s[20:23], s61 offen offset:512
L_hs_p1v_d:
    s_lshl_b32 s32, s18, 9
    s_lshl_b32 s33, s56, 8
    s_add_u32 s32, s32, s33
    s_lshl_b32 s33, s19, 1
    s_add_u32 s33, s33, s55
    s_lshl_b32 s33, s33, 2
    s_add_u32 s32, s32, s33
    s_add_u32 s32, s32, 29122560
    s_waitcnt vmcnt(0)
    v_mov_b32 v3, 0
    v_mov_b32 v4, 1
    s_mov_b64 exec, 1
    s_cmp_eq_u32 s63, -1
    s_cbranch_scc1 L_hs_f1_f
    buffer_store_dword v4, v3, s[20:23], s32 offen sc1
    s_branch L_hs_f1_d
L_hs_f1_f:
    buffer_store_dword v4, v3, s[20:23], s32 offen
L_hs_f1_d:
    s_mov_b64 exec, -1
L_p1_done:
    s_lshl_b32 s59, s41, 16
    s_lshl_b32 s60, s40, 10
    s_add_u32 s59, s59, s60
    s_lshl_b32 s61, s42, 13
    s_add_u32 s46, s59, s61
    s_add_u32 s59, s59, 2097152
    s_mov_b32 s61, 0
    s_mov_b32 s39, s46
    s_mov_b32 s68, s24
    s_mov_b32 s69, s25
    s_mov_b32 s70, 0x1c0000
    s_mov_b32 s71, 0x00020000
    s_mov_b32 s72, s26
    s_mov_b32 s73, s27
    s_mov_b32 s74, 0x1c0000
    s_mov_b32 s75, 0x00020000
    v_mov_b32 v114, 0
    v_mov_b32 v113, 0
    s_mov_b32 s55, 0
    s_cmp_ge_u32 s40, 4
    s_cbranch_scc1 L_f_nopack
    s_lshl_b32 s51, s2, 2
    s_add_u32 s51, s51, s40
    s_cmp_ge_u32 s51, 736
    s_cbranch_scc1 L_f_nopack
    s_lshl_b32 s52, s40, 13
    s_add_u32 s52, s52, 131072
    v_lshrrev_b32 v3, 2, v1
    v_and_b32 v4, 3, v1
    s_cmp_ge_u32 s51, 448
    s_cbranch_scc1 L_f_packn
    s_mov_b32 s55, 1
    v_mul_u32_u24 v3, 3584, v3
    v_lshl_add_u32 v114, v4, 4, v3
    s_and_b32 s43, s51, 7
    s_lshr_b32 s44, s51, 3
    s_mul_i32 s36, s43, 229376
    s_lshl_b32 s45, s44, 6
    s_add_u32 s36, s36, s45
    s_mov_b32 s37, s36
    s_mov_b32 s38, 57344
    s_lshl_b32 s45, s44, 1
    s_mul_i32 s58, s45, 9363
    s_lshr_b32 s58, s58, 16
    s_mul_i32 s53, s58, 7
    s_sub_u32 s53, s45, s53
    s_mul_i32 s58, s58, 224
    s_add_u32 s53, s53, s58
    s_mul_i32 s58, s43, 28
    s_add_u32 s53, s53, s58
    s_lshl_b32 s53, s53, 10
    s_add_u32 s53, s53, 20971520
    s_lshl_b32 s45, s44, 1
    s_add_u32 s45, s45, 1
    s_mul_i32 s58, s45, 9363
    s_lshr_b32 s58, s58, 16
    s_mul_i32 s54, s58, 7
    s_sub_u32 s54, s45, s54
    s_mul_i32 s58, s58, 224
    s_add_u32 s54, s54, s58
    s_mul_i32 s58, s43, 28
    s_add_u32 s54, s54, s58
    s_lshl_b32 s54, s54, 10
    s_add_u32 s54, s54, 20971520
    s_lshl_b32 s58, s44, 11
    s_lshr_b32 s45, s43, 2
    s_lshl_b32 s45, s45, 9
    s_add_u32 s58, s58, s45
    s_and_b32 s45, s43, 3
    s_lshl_b32 s45, s45, 2
    s_add_u32 s58, s58, s45
    s_add_u32 s58, s58, 25165824
    s_branch L_f_nopack
L_f_packn:
    s_mov_b32 s55, 2
    v_lshlrev_b32 v3, 10, v3
    v_lshl_add_u32 v114, v4, 4, v3
    s_cmp_ge_u32 s51, 512
    s_cbranch_scc1 L_f_packd
    s_mov_b32 s68, s4
    s_mov_b32 s69, s5
    s_mov_b32 s70, 0x80000
    s_mov_b32 s71, 0x00020000
    s_mov_b32 s72, s4
    s_mov_b32 s73, s5
    s_mov_b32 s74, 0x80000
    s_mov_b32 s75, 0x00020000
    s_sub_u32 s43, s51, 448
    s_lshr_b32 s44, s43, 2
    s_and_b32 s43, s43, 3
    s_lshl_b32 s53, s44, 15
    s_add_u32 s53, s53, 17825792
    s_branch L_f_packc
L_f_packd:
    s_mov_b32 s68, s6
    s_mov_b32 s69, s7
    s_mov_b32 s70, 0x1c0000
    s_mov_b32 s71, 0x00020000
    s_mov_b32 s72, s6
    s_mov_b32 s73, s7
    s_mov_b32 s74, 0x1c0000
    s_mov_b32 s75, 0x00020000
    s_sub_u32 s43, s51, 512
    s_mul_i32 s44, s43, 4682
    s_lshr_b32 s44, s44, 16
    s_mul_i32 s45, s44, 14
    s_sub_u32 s43, s43, s45
    s_mul_i32 s53, s44, 114688
    s_add_u32 s53, s53, 18874368
L_f_packc:
    s_lshl_b32 s45, s43, 13
    s_add_u32 s53, s53, s45
    s_lshl_b32 s36, s43, 17
    s_lshl_b32 s45, s44, 6
    s_add_u32 s36, s36, s45
    s_add_u32 s37, s36, 16384
    s_mov_b32 s38, 32768
L_f_nopack:
    s_mov_b32 s56, 0x0000ffff
    s_mov_b32 s57, 0x0000ffff
    v_and_b32 v3, 27, v1
    v_cmp_eq_u32 vcc, 16, v3
    v_mov_b32 v4, 0x3f803f80
    s_nop 1
    v_cndmask_b32 v24, 0, v4, vcc
    v_mov_b32 v25, v24
    v_mov_b32 v26, v24
    v_mov_b32 v27, v24
    v_mov_b32 v28, v24
    v_mov_b32 v29, v24
    v_mov_b32 v30, v24
    v_mov_b32 v31, v24
    v_mov_b32 v32, v24
    v_mov_b32 v33, v24
    v_mov_b32 v34, v24
    v_mov_b32 v35, v24
    v_mov_b32 v36, v24
    v_mov_b32 v37, v24
    v_mov_b32 v38, v24
    v_mov_b32 v39, v24
    s_mov_b32 s48, 7
    s_mov_b32 s49, 0
    s_mov_b32 s50, 1
    s_setprio 3
    s_barrier
    buffer_load_dwordx4 v[12:15], v2, s[20:23], s39 offen sc1
    s_add_u32 s46, s59, s61
    s_add_u32 m0, s60, 0
    s_add_u32 s61, s61, 8192
    buffer_load_dwordx4 v2, s[20:23], s46 offen sc1 lds
    s_add_u32 s46, s46, 2097152
    s_add_u32 m0, s60, 65536
    s_and_b32 s61, s61, 0xffff
    buffer_load_dwordx4 v2, s[20:23], s46 offen sc1 lds
    s_add_u32 s46, s59, s61
    s_add_u32 m0, s60, 8192
    s_add_u32 s61, s61, 8192
    buffer_load_dwordx4 v2, s[20:23], s46 offen sc1 lds
    s_add_u32 s46, s46, 2097152
    s_add_u32 m0, s60, 73728
    s_and_b32 s61, s61, 0xffff
    buffer_load_dwordx4 v2, s[20:23], s46 offen sc1 lds
    s_waitcnt vmcnt(2)
    s_barrier
L_f_maxpass:
    v_mov_b32 v112, 0xff800000
    v_mov_b32 v10, v2
L_f_mloop:
    ds_read_b128 v[16:19], v10
    v_add_u32 v10, 1024, v10
    s_waitcnt lgkmcnt(0)
    v_mfma_f32_32x32x16_bf16 v[64:79], v[16:19], v[12:15], 0
    s_nop 15
    v_max3_f32 v112, v64, v65, v112
    v_max3_f32 v112, v66, v67, v112
    v_max3_f32 v112, v68, v69, v112
    v_max3_f32 v112, v70, v71, v112
    v_max3_f32 v112, v72, v73, v112
    v_max3_f32 v112, v74, v75, v112
    v_max3_f32 v112, v76, v77, v112
    v_max3_f32 v112, v78, v79, v112
    s_sub_u32 s50, s50, 1
    s_cmp_lg_u32 s50, 0
    s_cbranch_scc1 L_f_mloop
    v_mov_b32 v10, v2
    v_lshrrev_b32 v3, 5, v1
    v_lshlrev_b32 v3, 8, v3
    v_and_b32 v4, 15, v1
    v_lshl_add_u32 v11, v4, 4, v3
    v_add_u32 v11, 65536, v11
    ds_read_b128 v[16:19], v10
    ds_read_b128 v[20:23], v10 offset:1024
    s_mov_b64 exec, s[56:57]
    ds_read_b128 v[24:27], v11
    ds_read_b128 v[28:31], v11 offset:512
    s_mov_b64 exec, -1
    v_mov_b32 v3, v112
    s_nop 1
    v_permlane32_swap_b32 v112, v3
    s_nop 1
    v_max_f32 v112, v112, v3
    v_sub_f32 v48, 0, v112
    v_sub_f32 v49, 0, v112
    v_sub_f32 v50, 0, v112
    v_sub_f32 v51, 0, v112
    v_sub_f32 v52, 0, v112
    v_sub_f32 v53, 0, v112
    v_sub_f32 v54, 0, v112
    v_sub_f32 v55, 0, v112
    v_sub_f32 v56, 0, v112
    v_sub_f32 v57, 0, v112
    v_sub_f32 v58, 0, v112
    v_sub_f32 v59, 0, v112
    v_sub_f32 v60, 0, v112
    v_sub_f32 v61, 0, v112
    v_sub_f32 v62, 0, v112
    v_sub_f32 v63, 0, v112
    s_waitcnt lgkmcnt(0)
    s_nop 0
    v_mfma_f32_32x32x16_bf16 v[64:79], v[16:19], v[12:15], v[48:63]
    v_mov_b32 v96, 0
    v_mov_b32 v97, 0
    v_mov_b32 v98, 0
    v_mov_b32 v99, 0
    v_mov_b32 v100, 0
    v_mov_b32 v101, 0
    v_mov_b32 v102, 0
    v_mov_b32 v103, 0
    v_mov_b32 v104, 0
    v_mov_b32 v105, 0
    v_mov_b32 v106, 0
    v_mov_b32 v107, 0
    v_mov_b32 v108, 0
    v_mov_b32 v109, 0
    v_mov_b32 v110, 0
    v_mov_b32 v111, 0
    v_mov_b32 v44, 0
    v_mov_b32 v45, 0
    v_mov_b32 v46, 0
    v_mov_b32 v47, 0
    s_mov_b32 s47, 8
    s_cmp_lg_u32 s49, 0
    s_cbranch_scc1 L_f_loop
    v_exp_f32 v64, v64
    v_exp_f32 v65, v65
    v_mfma_f32_32x32x16_bf16 v[96:111], v[36:39], v[44:47], v[96:111]
    v_exp_f32 v66, v66
    s_waitcnt lgkmcnt(0)
    ds_read_b128 v[16:19], v10 offset:2048
    v_exp_f32 v67, v67
    s_mov_b64 exec, s[56:57]
    ds_read_b128 v[32:35], v11 offset:1024
    ds_read_b128 v[36:39], v11 offset:1536
    s_mov_b64 exec, -1
    v_cvt_pk_bf16_f32 v40, v64, v65
    v_exp_f32 v68, v68
    v_exp_f32 v69, v69
    v_cvt_pk_bf16_f32 v41, v66, v67
    v_exp_f32 v70, v70
    v_exp_f32 v71, v71
    v_mfma_f32_32x32x16_bf16 v[80:95], v[20:23], v[12:15], v[48:63]
    v_cvt_pk_bf16_f32 v42, v68, v69
    v_exp_f32 v72, v72
    s_add_u32 s46, s59, s61
    s_add_u32 m0, s60, 16384
    s_add_u32 s61, s61, 8192
    buffer_load_dwordx4 v2, s[20:23], s46 offen sc1 lds
    v_exp_f32 v73, v73
    v_cvt_pk_bf16_f32 v43, v70, v71
    v_exp_f32 v74, v74
    v_exp_f32 v75, v75
    v_cvt_pk_bf16_f32 v44, v72, v73
    v_exp_f32 v76, v76
    v_exp_f32 v77, v77
    v_mfma_f32_32x32x16_bf16 v[96:111], v[24:27], v[40:43], v[96:111]
    v_cvt_pk_bf16_f32 v45, v74, v75
    v_exp_f32 v78, v78
    s_add_u32 s46, s46, 2097152
    s_add_u32 m0, s60, 81920
    s_and_b32 s61, s61, 0xffff
    buffer_load_dwordx4 v2, s[20:23], s46 offen sc1 lds
    v_exp_f32 v79, v79
    v_cvt_pk_bf16_f32 v46, v76, v77
    v_cvt_pk_bf16_f32 v47, v78, v79
    v_exp_f32 v80, v80
    v_exp_f32 v81, v81
    v_mfma_f32_32x32x16_bf16 v[96:111], v[28:31], v[44:47], v[96:111]
    v_exp_f32 v82, v82
    s_waitcnt lgkmcnt(0)
    ds_read_b128 v[20:23], v10 offset:3072
    v_exp_f32 v83, v83
    s_mov_b64 exec, s[56:57]
    ds_read_b128 v[24:27], v11 offset:2048
    ds_read_b128 v[28:31], v11 offset:2560
    s_mov_b64 exec, -1
    v_cvt_pk_bf16_f32 v40, v80, v81
    v_exp_f32 v84, v84
    v_exp_f32 v85, v85
    v_cvt_pk_bf16_f32 v41, v82, v83
    v_exp_f32 v86, v86
    v_exp_f32 v87, v87
    v_mfma_f32_32x32x16_bf16 v[64:79], v[16:19], v[12:15], v[48:63]
    v_cvt_pk_bf16_f32 v42, v84, v85
    v_exp_f32 v88, v88
    s_add_u32 s46, s59, s61
    s_add_u32 m0, s60, 24576
    s_add_u32 s61, s61, 8192
    buffer_load_dwordx4 v2, s[20:23], s46 offen sc1 lds
    v_exp_f32 v89, v89
    v_cvt_pk_bf16_f32 v43, v86, v87
    v_exp_f32 v90, v90
    v_exp_f32 v91, v91
    v_cvt_pk_bf16_f32 v44, v88, v89
    v_exp_f32 v92, v92
    v_exp_f32 v93, v93
    v_mfma_f32_32x32x16_bf16 v[96:111], v[32:35], v[40:43], v[96:111]
    v_cvt_pk_bf16_f32 v45, v90, v91
    v_exp_f32 v94, v94
    s_add_u32 s46, s46, 2097152
    s_add_u32 m0, s60, 90112
    s_and_b32 s61, s61, 0xffff
    buffer_load_dwordx4 v2, s[20:23], s46 offen sc1 lds
    v_exp_f32 v95, v95
    v_cvt_pk_bf16_f32 v46, v92, v93
    v_cvt_pk_bf16_f32 v47, v94, v95
    v_exp_f32 v64, v64
    v_exp_f32 v65, v65
    v_mfma_f32_32x32x16_bf16 v[96:111], v[36:39], v[44:47], v[96:111]
    v_exp_f32 v66, v66
    s_waitcnt lgkmcnt(0)
    ds_read_b128 v[16:19], v10 offset:4096
    v_exp_f32 v67, v67
    s_mov_b64 exec, s[56:57]
    ds_read_b128 v[32:35], v11 offset:3072
    ds_read_b128 v[36:39], v11 offset:3584
    s_mov_b64 exec, -1
    v_cvt_pk_bf16_f32 v40, v64, v65
    v_exp_f32 v68, v68
    v_exp_f32 v69, v69
    v_cvt_pk_bf16_f32 v41, v66, v67
    v_exp_f32 v70, v70
    v_exp_f32 v71, v71
    v_mfma_f32_32x32x16_bf16 v[80:95], v[20:23], v[12:15], v[48:63]
    v_cvt_pk_bf16_f32 v42, v68, v69
    v_exp_f32 v72, v72
    s_add_u32 s46, s59, s61
    s_add_u32 m0, s60, 32768
    s_add_u32 s61, s61, 8192
    buffer_load_dwordx4 v2, s[20:23], s46 offen sc1 lds
    v_exp_f32 v73, v73
    v_cvt_pk_bf16_f32 v43, v70, v71
    v_exp_f32 v74, v74
    v_exp_f32 v75, v75
    v_cvt_pk_bf16_f32 v44, v72, v73
    v_exp_f32 v76, v76
    v_exp_f32 v77, v77
    v_mfma_f32_32x32x16_bf16 v[96:111], v[24:27], v[40:43], v[96:111]
    v_cvt_pk_bf16_f32 v45, v74, v75
    v_exp_f32 v78, v78
    s_add_u32 s46, s46, 2097152
    s_add_u32 m0, s60, 98304
    s_and_b32 s61, s61, 0xffff
    buffer_load_dwordx4 v2, s[20:23], s46 offen sc1 lds
    v_exp_f32 v79, v79
    v_cvt_pk_bf16_f32 v46, v76, v77
    v_cvt_pk_bf16_f32 v47, v78, v79
    v_exp_f32 v80, v80
    v_exp_f32 v81, v81
    v_mfma_f32_32x32x16_bf16 v[96:111], v[28:31], v[44:47], v[96:111]
    v_exp_f32 v82, v82
    s_waitcnt lgkmcnt(0)
    ds_read_b128 v[20:23], v10 offset:5120
    v_exp_f32 v83, v83
    s_mov_b64 exec, s[56:57]
    ds_read_b128 v[24:27], v11 offset:4096
    ds_read_b128 v[28:31], v11 offset:4608
    s_mov_b64 exec, -1
    v_cvt_pk_bf16_f32 v40, v80, v81
    v_exp_f32 v84, v84
    v_exp_f32 v85, v85
    v_cvt_pk_bf16_f32 v41, v82, v83
    v_exp_f32 v86, v86
    v_exp_f32 v87, v87
    v_mfma_f32_32x32x16_bf16 v[64:79], v[16:19], v[12:15], v[48:63]
    v_cvt_pk_bf16_f32 v42, v84, v85
    v_exp_f32 v88, v88
    s_add_u32 s46, s59, s61
    s_add_u32 m0, s60, 40960
    s_add_u32 s61, s61, 8192
    buffer_load_dwordx4 v2, s[20:23], s46 offen sc1 lds
    v_exp_f32 v89, v89
    v_cvt_pk_bf16_f32 v43, v86, v87
    v_exp_f32 v90, v90
    v_exp_f32 v91, v91
    v_cvt_pk_bf16_f32 v44, v88, v89
    v_exp_f32 v92, v92
    v_exp_f32 v93, v93
    v_mfma_f32_32x32x16_bf16 v[96:111], v[32:35], v[40:43], v[96:111]
    v_cvt_pk_bf16_f32 v45, v90, v91
    v_exp_f32 v94, v94
    s_add_u32 s46, s46, 2097152
    s_add_u32 m0, s60, 106496
    s_and_b32 s61, s61, 0xffff
    buffer_load_dwordx4 v2, s[20:23], s46 offen sc1 lds
    v_exp_f32 v95, v95
    v_cvt_pk_bf16_f32 v46, v92, v93
    v_cvt_pk_bf16_f32 v47, v94, v95
    v_exp_f32 v64, v64
    v_exp_f32 v65, v65
    v_mfma_f32_32x32x16_bf16 v[96:111], v[36:39], v[44:47], v[96:111]
    v_exp_f32 v66, v66
    s_waitcnt lgkmcnt(0)
    ds_read_b128 v[16:19], v10 offset:6144
    v_exp_f32 v67, v67
    s_mov_b64 exec, s[56:57]
    ds_read_b128 v[32:35], v11 offset:5120
    ds_read_b128 v[36:39], v11 offset:5632
    s_mov_b64 exec, -1
    v_cvt_pk_bf16_f32 v40, v64, v65
    v_exp_f32 v68, v68
    v_exp_f32 v69, v69
    v_cvt_pk_bf16_f32 v41, v66, v67
    v_exp_f32 v70, v70
    v_exp_f32 v71, v71
    v_mfma_f32_32x32x16_bf16 v[80:95], v[20:23], v[12:15], v[48:63]
    v_cvt_pk_bf16_f32 v42, v68, v69
    v_exp_f32 v72, v72
    s_add_u32 s46, s59, s61
    s_add_u32 m0, s60, 49152
    s_add_u32 s61, s61, 8192
    buffer_load_dwordx4 v2, s[20:23], s46 offen sc1 lds
    v_exp_f32 v73, v73
    v_cvt_pk_bf16_f32 v43, v70, v71
    v_exp_f32 v74, v74
    v_exp_f32 v75, v75
    v_cvt_pk_bf16_f32 v44, v72, v73
    v_exp_f32 v76, v76
    v_exp_f32 v77, v77
    v_mfma_f32_32x32x16_bf16 v[96:111], v[24:27], v[40:43], v[96:111]
    v_cvt_pk_bf16_f32 v45, v74, v75
    v_exp_f32 v78, v78
    s_add_u32 s46, s46, 2097152
    s_add_u32 m0, s60, 114688
    s_and_b32 s61, s61, 0xffff
    buffer_load_dwordx4 v2, s[20:23], s46 offen sc1 lds
    v_exp_f32 v79, v79
    v_cvt_pk_bf16_f32 v46, v76, v77
    v_cvt_pk_bf16_f32 v47, v78, v79
    v_exp_f32 v80, v80
    v_exp_f32 v81, v81
    v_mfma_f32_32x32x16_bf16 v[96:111], v[28:31], v[44:47], v[96:111]
    v_exp_f32 v82, v82
    s_waitcnt lgkmcnt(0)
    ds_read_b128 v[20:23], v10 offset:7168
    v_exp_f32 v83, v83
    s_mov_b64 exec, s[56:57]
    ds_read_b128 v[24:27], v11 offset:6144
    ds_read_b128 v[28:31], v11 offset:6656
    s_mov_b64 exec, -1
    v_cvt_pk_bf16_f32 v40, v80, v81
    v_exp_f32 v84, v84
    v_exp_f32 v85, v85
    v_cvt_pk_bf16_f32 v41, v82, v83
    v_exp_f32 v86, v86
    v_exp_f32 v87, v87
    v_mfma_f32_32x32x16_bf16 v[64:79], v[16:19], v[12:15], v[48:63]
    v_cvt_pk_bf16_f32 v42, v84, v85
    v_exp_f32 v88, v88
    s_add_u32 s46, s59, s61
    s_add_u32 m0, s60, 57344
    s_add_u32 s61, s61, 8192
    buffer_load_dwordx4 v2, s[20:23], s46 offen sc1 lds
    v_exp_f32 v89, v89
    v_cvt_pk_bf16_f32 v43, v86, v87
    v_exp_f32 v90, v90
    v_exp_f32 v91, v91
    v_cvt_pk_bf16_f32 v44, v88, v89
    v_exp_f32 v92, v92
    v_exp_f32 v93, v93
    v_mfma_f32_32x32x16_bf16 v[96:111], v[32:35], v[40:43], v[96:111]
    v_cvt_pk_bf16_f32 v45, v90, v91
    v_exp_f32 v94, v94
    s_add_u32 s46, s46, 2097152
    s_add_u32 m0, s60, 122880
    s_and_b32 s61, s61, 0xffff
    buffer_load_dwordx4 v2, s[20:23], s46 offen sc1 lds
    v_exp_f32 v95, v95
    v_cvt_pk_bf16_f32 v46, v92, v93
    v_cvt_pk_bf16_f32 v47, v94, v95
    s_waitcnt vmcnt(12)
    s_barrier
    v_exp_f32 v64, v64
    v_exp_f32 v65, v65
    v_mfma_f32_32x32x16_bf16 v[96:111], v[36:39], v[44:47], v[96:111]
    v_exp_f32 v66, v66
    s_waitcnt lgkmcnt(0)
    ds_read_b128 v[16:19], v10 offset:8192
    v_exp_f32 v67, v67
    s_mov_b64 exec, s[56:57]
    ds_read_b128 v[32:35], v11 offset:7168
    ds_read_b128 v[36:39], v11 offset:7680
    s_mov_b64 exec, -1
    v_cvt_pk_bf16_f32 v40, v64, v65
    v_exp_f32 v68, v68
    v_exp_f32 v69, v69
    v_cvt_pk_bf16_f32 v41, v66, v67
    v_exp_f32 v70, v70
    v_exp_f32 v71, v71
    v_mfma_f32_32x32x16_bf16 v[80:95], v[20:23], v[12:15], v[48:63]
    v_cvt_pk_bf16_f32 v42, v68, v69
    v_exp_f32 v72, v72
    s_cmp_eq_u32 s55, 0
    s_cbranch_scc1 L_f_np6
    s_add_u32 m0, s52, 0
    s_nop 0
    buffer_load_dwordx4 v114, s[68:71], s36 offen lds
    s_add_u32 s36, s36, s38
    s_add_u32 m0, s52, 1024
    s_nop 0
    buffer_load_dwordx4 v114, s[72:75], s37 offen lds
    s_add_u32 s37, s37, s38
    s_add_u32 m0, s52, 2048
    s_nop 0
    buffer_load_dwordx4 v114, s[68:71], s36 offen lds
    s_add_u32 s36, s36, s38
    s_add_u32 m0, s52, 3072
    s_nop 0
    buffer_load_dwordx4 v114, s[72:75], s37 offen lds
    s_add_u32 s37, s37, s38
L_f_np6:
    v_exp_f32 v73, v73
    v_cvt_pk_bf16_f32 v43, v70, v71
    v_exp_f32 v74, v74
    v_exp_f32 v75, v75
    v_cvt_pk_bf16_f32 v44, v72, v73
    v_exp_f32 v76, v76
    v_exp_f32 v77, v77
    v_mfma_f32_32x32x16_bf16 v[96:111], v[24:27], v[40:43], v[96:111]
    v_cvt_pk_bf16_f32 v45, v74, v75
    v_exp_f32 v78, v78
    v_exp_f32 v79, v79
    v_cvt_pk_bf16_f32 v46, v76, v77
    v_cvt_pk_bf16_f32 v47, v78, v79
    v_exp_f32 v80, v80
    v_exp_f32 v81, v81
    v_mfma_f32_32x32x16_bf16 v[96:111], v[28:31], v[44:47], v[96:111]
    v_exp_f32 v82, v82
    s_waitcnt lgkmcnt(0)
    ds_read_b128 v[20:23], v10 offset:9216
    v_exp_f32 v83, v83
    s_mov_b64 exec, s[56:57]
    ds_read_b128 v[24:27], v11 offset:8192
    ds_read_b128 v[28:31], v11 offset:8704
    s_mov_b64 exec, -1
    v_cvt_pk_bf16_f32 v40, v80, v81
    v_exp_f32 v84, v84
    v_exp_f32 v85, v85
    v_cvt_pk_bf16_f32 v41, v82, v83
    v_exp_f32 v86, v86
    v_exp_f32 v87, v87
    v_mfma_f32_32x32x16_bf16 v[64:79], v[16:19], v[12:15], v[48:63]
    v_cvt_pk_bf16_f32 v42, v84, v85
    v_exp_f32 v88, v88
    s_cmp_eq_u32 s55, 0
    s_cbranch_scc1 L_f_np7
    s_add_u32 m0, s52, 4096
    s_nop 0
    buffer_load_dwordx4 v114, s[68:71], s36 offen lds
    s_add_u32 s36, s36, s38
    s_add_u32 m0, s52, 5120
    s_nop 0
    buffer_load_dwordx4 v114, s[72:75], s37 offen lds
    s_add_u32 s37, s37, s38
    s_add_u32 m0, s52, 6144
    s_nop 0
    buffer_load_dwordx4 v114, s[68:71], s36 offen lds
    s_add_u32 s36, s36, s38
    s_add_u32 m0, s52, 7168
    s_nop 0
    buffer_load_dwordx4 v114, s[72:75], s37 offen lds
    s_add_u32 s37, s37, s38
L_f_np7:
    v_exp_f32 v89, v89
    v_cvt_pk_bf16_f32 v43, v86, v87
    v_exp_f32 v90, v90
    v_exp_f32 v91, v91
    v_cvt_pk_bf16_f32 v44, v88, v89
    v_exp_f32 v92, v92
    v_exp_f32 v93, v93
    v_mfma_f32_32x32x16_bf16 v[96:111], v[32:35], v[40:43], v[96:111]
    v_cvt_pk_bf16_f32 v45, v90, v91
    v_exp_f32 v94, v94
    v_exp_f32 v95, v95
    v_cvt_pk_bf16_f32 v46, v92, v93
    v_add_u32 v10, 8192, v10
    v_add_u32 v11, 8192, v11
    s_sub_u32 s47, s47, 1
    s_cmp_lg_u32 s47, 0
    v_cvt_pk_bf16_f32 v47, v94, v95
.p2align 6
L_f_loop:
    v_exp_f32 v64, v64
    v_exp_f32 v65, v65
    v_mfma_f32_32x32x16_bf16 v[96:111], v[36:39], v[44:47], v[96:111]
    v_exp_f32 v66, v66
    s_waitcnt lgkmcnt(0)
    ds_read_b128 v[16:19], v10 offset:2048
    v_exp_f32 v67, v67
    s_mov_b64 exec, s[56:57]
    ds_read_b128 v[32:35], v11 offset:1024
    ds_read_b128 v[36:39], v11 offset:1536
    s_mov_b64 exec, -1
    v_cvt_pk_bf16_f32 v40, v64, v65
    v_exp_f32 v68, v68
    v_exp_f32 v69, v69
    v_cvt_pk_bf16_f32 v41, v66, v67
    v_exp_f32 v70, v70
    v_exp_f32 v71, v71
    v_mfma_f32_32x32x16_bf16 v[80:95], v[20:23], v[12:15], v[48:63]
    v_cvt_pk_bf16_f32 v42, v68, v69
    v_exp_f32 v72, v72
    s_cmp_lg_u32 s47, 5
    s_cbranch_scc1 L_f_pp0
    s_setprio 2
L_f_pp0:
    s_cmp_lg_u32 s47, 2
    s_cbranch_scc1 L_f_pp1
    s_setprio 1
L_f_pp1:
    s_cmp_lg_u32 s47, 1
    s_cbranch_scc1 L_f_pp2
    s_setprio 0
L_f_pp2:
    v_exp_f32 v73, v73
    v_cvt_pk_bf16_f32 v43, v70, v71
    v_exp_f32 v74, v74
    v_exp_f32 v75, v75
    v_cvt_pk_bf16_f32 v44, v72, v73
    v_exp_f32 v76, v76
    v_exp_f32 v77, v77
    v_mfma_f32_32x32x16_bf16 v[96:111], v[24:27], v[40:43], v[96:111]
    v_cvt_pk_bf16_f32 v45, v74, v75
    v_exp_f32 v78, v78
    v_exp_f32 v79, v79
    v_cvt_pk_bf16_f32 v46, v76, v77
    v_cvt_pk_bf16_f32 v47, v78, v79
    v_exp_f32 v80, v80
    v_exp_f32 v81, v81
    v_mfma_f32_32x32x16_bf16 v[96:111], v[28:31], v[44:47], v[96:111]
    v_exp_f32 v82, v82
    s_waitcnt lgkmcnt(0)
    ds_read_b128 v[20:23], v10 offset:3072
    v_exp_f32 v83, v83
    s_mov_b64 exec, s[56:57]
    ds_read_b128 v[24:27], v11 offset:2048
    ds_read_b128 v[28:31], v11 offset:2560
    s_mov_b64 exec, -1
    v_cvt_pk_bf16_f32 v40, v80, v81
    v_exp_f32 v84, v84
    v_exp_f32 v85, v85
    v_cvt_pk_bf16_f32 v41, v82, v83
    v_exp_f32 v86, v86
    v_exp_f32 v87, v87
    v_mfma_f32_32x32x16_bf16 v[64:79], v[16:19], v[12:15], v[48:63]
    v_cvt_pk_bf16_f32 v42, v84, v85
    v_exp_f32 v88, v88
    v_exp_f32 v89, v89
    v_cvt_pk_bf16_f32 v43, v86, v87
    v_exp_f32 v90, v90
    v_exp_f32 v91, v91
    v_cvt_pk_bf16_f32 v44, v88, v89
    v_exp_f32 v92, v92
    v_exp_f32 v93, v93
    v_mfma_f32_32x32x16_bf16 v[96:111], v[32:35], v[40:43], v[96:111]
    v_cvt_pk_bf16_f32 v45, v90, v91
    v_exp_f32 v94, v94
    v_exp_f32 v95, v95
    v_cvt_pk_bf16_f32 v46, v92, v93
    v_cvt_pk_bf16_f32 v47, v94, v95
    v_exp_f32 v64, v64
    v_exp_f32 v65, v65
    v_mfma_f32_32x32x16_bf16 v[96:111], v[36:39], v[44:47], v[96:111]
    v_exp_f32 v66, v66
    s_waitcnt lgkmcnt(0)
    ds_read_b128 v[16:19], v10 offset:4096
    v_exp_f32 v67, v67
    s_mov_b64 exec, s[56:57]
    ds_read_b128 v[32:35], v11 offset:3072
    ds_read_b128 v[36:39], v11 offset:3584
    s_mov_b64 exec, -1
    v_cvt_pk_bf16_f32 v40, v64, v65
    v_exp_f32 v68, v68
    v_exp_f32 v69, v69
    v_cvt_pk_bf16_f32 v41, v66, v67
    v_exp_f32 v70, v70
    v_exp_f32 v71, v71
    v_mfma_f32_32x32x16_bf16 v[80:95], v[20:23], v[12:15], v[48:63]
    v_cvt_pk_bf16_f32 v42, v68, v69
    v_exp_f32 v72, v72
    v_exp_f32 v73, v73
    v_cvt_pk_bf16_f32 v43, v70, v71
    v_exp_f32 v74, v74
    v_exp_f32 v75, v75
    v_cvt_pk_bf16_f32 v44, v72, v73
    v_exp_f32 v76, v76
    v_exp_f32 v77, v77
    v_mfma_f32_32x32x16_bf16 v[96:111], v[24:27], v[40:43], v[96:111]
    v_cvt_pk_bf16_f32 v45, v74, v75
    v_exp_f32 v78, v78
    v_exp_f32 v79, v79
    v_cvt_pk_bf16_f32 v46, v76, v77
    v_cvt_pk_bf16_f32 v47, v78, v79
    v_exp_f32 v80, v80
    v_exp_f32 v81, v81
    v_mfma_f32_32x32x16_bf16 v[96:111], v[28:31], v[44:47], v[96:111]
    v_exp_f32 v82, v82
    s_waitcnt lgkmcnt(0)
    ds_read_b128 v[20:23], v10 offset:5120
    v_exp_f32 v83, v83
    s_mov_b64 exec, s[56:57]
    ds_read_b128 v[24:27], v11 offset:4096
    ds_read_b128 v[28:31], v11 offset:4608
    s_mov_b64 exec, -1
    v_cvt_pk_bf16_f32 v40, v80, v81
    v_exp_f32 v84, v84
    v_exp_f32 v85, v85
    v_cvt_pk_bf16_f32 v41, v82, v83
    v_exp_f32 v86, v86
    v_exp_f32 v87, v87
    v_mfma_f32_32x32x16_bf16 v[64:79], v[16:19], v[12:15], v[48:63]
    v_cvt_pk_bf16_f32 v42, v84, v85
    v_exp_f32 v88, v88
    v_exp_f32 v89, v89
    v_cvt_pk_bf16_f32 v43, v86, v87
    v_exp_f32 v90, v90
    v_exp_f32 v91, v91
    v_cvt_pk_bf16_f32 v44, v88, v89
    v_exp_f32 v92, v92
    v_exp_f32 v93, v93
    v_mfma_f32_32x32x16_bf16 v[96:111], v[32:35], v[40:43], v[96:111]
    v_cvt_pk_bf16_f32 v45, v90, v91
    v_exp_f32 v94, v94
    v_exp_f32 v95, v95
    v_cvt_pk_bf16_f32 v46, v92, v93
    v_cvt_pk_bf16_f32 v47, v94, v95
    v_exp_f32 v64, v64
    v_exp_f32 v65, v65
    v_mfma_f32_32x32x16_bf16 v[96:111], v[36:39], v[44:47], v[96:111]
    v_exp_f32 v66, v66
    s_waitcnt lgkmcnt(0)
    ds_read_b128 v[16:19], v10 offset:6144
    v_exp_f32 v67, v67
    s_mov_b64 exec, s[56:57]
    ds_read_b128 v[32:35], v11 offset:5120
    ds_read_b128 v[36:39], v11 offset:5632
    s_mov_b64 exec, -1
    v_cvt_pk_bf16_f32 v40, v64, v65
    v_exp_f32 v68, v68
    v_exp_f32 v69, v69
    v_cvt_pk_bf16_f32 v41, v66, v67
    v_exp_f32 v70, v70
    v_exp_f32 v71, v71
    v_mfma_f32_32x32x16_bf16 v[80:95], v[20:23], v[12:15], v[48:63]
    v_cvt_pk_bf16_f32 v42, v68, v69
    v_exp_f32 v72, v72
    v_exp_f32 v73, v73
    v_cvt_pk_bf16_f32 v43, v70, v71
    v_exp_f32 v74, v74
    v_exp_f32 v75, v75
    v_cvt_pk_bf16_f32 v44, v72, v73
    v_exp_f32 v76, v76
    v_exp_f32 v77, v77
    v_mfma_f32_32x32x16_bf16 v[96:111], v[24:27], v[40:43], v[96:111]
    v_cvt_pk_bf16_f32 v45, v74, v75
    v_exp_f32 v78, v78
    v_exp_f32 v79, v79
    v_cvt_pk_bf16_f32 v46, v76, v77
    v_cvt_pk_bf16_f32 v47, v78, v79
    v_exp_f32 v80, v80
    v_exp_f32 v81, v81
    v_mfma_f32_32x32x16_bf16 v[96:111], v[28:31], v[44:47], v[96:111]
    v_exp_f32 v82, v82
    s_waitcnt lgkmcnt(0)
    ds_read_b128 v[20:23], v10 offset:7168
    v_exp_f32 v83, v83
    s_mov_b64 exec, s[56:57]
    ds_read_b128 v[24:27], v11 offset:6144
    ds_read_b128 v[28:31], v11 offset:6656
    s_mov_b64 exec, -1
    v_cvt_pk_bf16_f32 v40, v80, v81
    v_exp_f32 v84, v84
    v_exp_f32 v85, v85
    v_cvt_pk_bf16_f32 v41, v82, v83
    v_exp_f32 v86, v86
    v_exp_f32 v87, v87
    v_mfma_f32_32x32x16_bf16 v[64:79], v[16:19], v[12:15], v[48:63]
    v_cvt_pk_bf16_f32 v42, v84, v85
    v_exp_f32 v88, v88
    v_exp_f32 v89, v89
    v_cvt_pk_bf16_f32 v43, v86, v87
    v_exp_f32 v90, v90
    v_exp_f32 v91, v91
    v_cvt_pk_bf16_f32 v44, v88, v89
    v_exp_f32 v92, v92
    v_exp_f32 v93, v93
    v_mfma_f32_32x32x16_bf16 v[96:111], v[32:35], v[40:43], v[96:111]
    v_cvt_pk_bf16_f32 v45, v90, v91
    v_exp_f32 v94, v94
    v_exp_f32 v95, v95
    v_cvt_pk_bf16_f32 v46, v92, v93
    v_cvt_pk_bf16_f32 v47, v94, v95
    s_cmp_eq_u32 s47, s48
    s_cbranch_scc1 L_f_event
L_f_syncret:
    v_exp_f32 v64, v64
    v_exp_f32 v65, v65
    v_mfma_f32_32x32x16_bf16 v[96:111], v[36:39], v[44:47], v[96:111]
    v_exp_f32 v66, v66
    s_waitcnt lgkmcnt(0)
    ds_read_b128 v[16:19], v10 offset:8192
    v_exp_f32 v67, v67
    s_mov_b64 exec, s[56:57]
    ds_read_b128 v[32:35], v11 offset:7168
    ds_read_b128 v[36:39], v11 offset:7680
    s_mov_b64 exec, -1
    v_cvt_pk_bf16_f32 v40, v64, v65
    v_exp_f32 v68, v68
    v_exp_f32 v69, v69
    v_cvt_pk_bf16_f32 v41, v66, v67
    v_exp_f32 v70, v70
    v_exp_f32 v71, v71
    v_mfma_f32_32x32x16_bf16 v[80:95], v[20:23], v[12:15], v[48:63]
    v_cvt_pk_bf16_f32 v42, v68, v69
    v_exp_f32 v72, v72
    v_exp_f32 v73, v73
    v_cvt_pk_bf16_f32 v43, v70, v71
    v_exp_f32 v74, v74
    v_exp_f32 v75, v75
    v_cvt_pk_bf16_f32 v44, v72, v73
    v_exp_f32 v76, v76
    v_exp_f32 v77, v77
    v_mfma_f32_32x32x16_bf16 v[96:111], v[24:27], v[40:43], v[96:111]
    v_cvt_pk_bf16_f32 v45, v74, v75
    v_exp_f32 v78, v78
    v_exp_f32 v79, v79
    v_cvt_pk_bf16_f32 v46, v76, v77
    v_cvt_pk_bf16_f32 v47, v78, v79
    v_exp_f32 v80, v80
    v_exp_f32 v81, v81
    v_mfma_f32_32x32x16_bf16 v[96:111], v[28:31], v[44:47], v[96:111]
    v_exp_f32 v82, v82
    s_waitcnt lgkmcnt(0)
    ds_read_b128 v[20:23], v10 offset:9216
    v_exp_f32 v83, v83
    s_mov_b64 exec, s[56:57]
    ds_read_b128 v[24:27], v11 offset:8192
    ds_read_b128 v[28:31], v11 offset:8704
    s_mov_b64 exec, -1
    v_cvt_pk_bf16_f32 v40, v80, v81
    v_exp_f32 v84, v84
    v_exp_f32 v85, v85
    v_cvt_pk_bf16_f32 v41, v82, v83
    v_exp_f32 v86, v86
    v_exp_f32 v87, v87
    v_mfma_f32_32x32x16_bf16 v[64:79], v[16:19], v[12:15], v[48:63]
    v_cvt_pk_bf16_f32 v42, v84, v85
    v_exp_f32 v88, v88
    v_exp_f32 v89, v89
    v_cvt_pk_bf16_f32 v43, v86, v87
    v_exp_f32 v90, v90
    v_exp_f32 v91, v91
    v_cvt_pk_bf16_f32 v44, v88, v89
    v_exp_f32 v92, v92
    v_exp_f32 v93, v93
    v_mfma_f32_32x32x16_bf16 v[96:111], v[32:35], v[40:43], v[96:111]
    v_cvt_pk_bf16_f32 v45, v90, v91
    v_exp_f32 v94, v94
    v_exp_f32 v95, v95
    v_cvt_pk_bf16_f32 v46, v92, v93
    v_add_u32 v10, 8192, v10
    v_add_u32 v11, 8192, v11
    s_sub_u32 s47, s47, 1
    s_cmp_lg_u32 s47, 0
    v_cvt_pk_bf16_f32 v47, v94, v95
    s_cbranch_scc1 L_f_loop
    s_nop 1
    v_mfma_f32_32x32x16_bf16 v[96:111], v[36:39], v[44:47], v[96:111]
    s_waitcnt lgkmcnt(0)
    s_lshl_b32 s43, s42, 3
    s_add_u32 s43, s43, s40
    s_lshl_b32 s43, s43, 5
    s_add_u32 s43, s43, s41
    s_lshl_b32 s43, s43, 10
    s_add_u32 s43, s43, 6291456
    s_nop 7
    v_mul_f32 v3, 0, v96
    v_fmac_f32 v3, 0, v97
    v_fmac_f32 v3, 0, v98
    v_fmac_f32 v3, 0, v99
    v_fmac_f32 v3, 0, v100
    v_fmac_f32 v3, 0, v101
    v_fmac_f32 v3, 0, v102
    v_fmac_f32 v3, 0, v103
    v_add_f32 v3, v3, v104
    v_cmp_gt_f32 vcc, 0x71800000, v3
    v_rcp_f32 v4, v104
    s_cmp_lg_u32 s49, 0
    s_cbranch_scc1 L_f_fin
    s_cmp_eq_u64 vcc, exec
    s_cbranch_scc1 L_f_fin
    s_mov_b32 s49, 1
    s_mov_b32 s50, 64
    s_branch L_f_maxpass
L_f_fin:
    v_mul_f32 v96, v4, v96
    v_mul_f32 v97, v4, v97
    v_mul_f32 v98, v4, v98
    v_mul_f32 v99, v4, v99
    v_mul_f32 v100, v4, v100
    v_mul_f32 v101, v4, v101
    v_mul_f32 v102, v4, v102
    v_mul_f32 v103, v4, v103
    v_cvt_pk_bf16_f32 v40, v96, v97
    v_cvt_pk_bf16_f32 v41, v98, v99
    v_cvt_pk_bf16_f32 v42, v100, v101
    v_cvt_pk_bf16_f32 v43, v102, v103
    buffer_store_dwordx4 v[40:43], v2, s[20:23], s43 offen sc1
    s_setprio 0
    s_mov_b32 s48, 0
    s_mov_b32 s55, 0
    s_mov_b32 s49, 0
    s_mov_b32 s50, 0
    s_mov_b32 s47, 0
    s_mov_b32 s43, 0xffff0000
    s_and_b32 s44, s40, 3
    s_lshl_b32 s51, s19, 3
    s_add_u32 s51, s51, s40
    s_lshl_b32 s32, s42, 2
    s_lshr_b32 s33, s40, 1
    s_add_u32 s32, s32, s33
    s_lshl_b32 s32, s32, 8
    s_and_b32 s33, s40, 1
    s_lshl_b32 s33, s33, 5
    s_add_u32 s33, s33, s41
    s_lshl_b32 s33, s33, 2
    s_add_u32 s33, s33, s32
    s_add_u32 s33, s33, 29097984
    s_mul_i32 s45, s44, 7168
    s_mul_i32 s46, s28, 229376
    s_add_u32 s46, s46, s45
    s_add_u32 s46, s46, 20971520
    s_waitcnt vmcnt(0)
    v_mov_b32 v3, 0
    v_mov_b32 v4, 1
    s_mov_b64 exec, 1
    buffer_store_dword v4, v3, s[20:23], s33 offen sc1
    s_mov_b64 exec, -1
    s_barrier
    s_cmp_ge_u32 s40, 4
    s_cbranch_scc1 L_f_a1
    s_add_u32 s34, s46, 0
    s_add_u32 m0, s45, 0
    s_add_u32 s35, s34, 4096
    buffer_load_dwordx4 v2, s[20:23], s34 offen offset:0 sc1 lds
    buffer_load_dwordx4 v2, s[20:23], s34 offen offset:1024 sc1 lds
    buffer_load_dwordx4 v2, s[20:23], s34 offen offset:2048 sc1 lds
    buffer_load_dwordx4 v2, s[20:23], s34 offen offset:3072 sc1 lds
    s_add_u32 m0, m0, 4096
    s_nop 0
    buffer_load_dwordx4 v2, s[20:23], s35 offen offset:0 sc1 lds
    buffer_load_dwordx4 v2, s[20:23], s35 offen offset:1024 sc1 lds
    buffer_load_dwordx4 v2, s[20:23], s35 offen offset:2048 sc1 lds
    s_add_u32 s34, s46, 28672
    s_add_u32 m0, s45, 28672
    s_add_u32 s35, s34, 4096
    buffer_load_dwordx4 v2, s[20:23], s34 offen offset:0 sc1 lds
    buffer_load_dwordx4 v2, s[20:23], s34 offen offset:1024 sc1 lds
    buffer_load_dwordx4 v2, s[20:23], s34 offen offset:2048 sc1 lds
    buffer_load_dwordx4 v2, s[20:23], s34 offen offset:3072 sc1 lds
    s_add_u32 m0, m0, 4096
    s_nop 0
    buffer_load_dwordx4 v2, s[20:23], s35 offen offset:0 sc1 lds
    buffer_load_dwordx4 v2, s[20:23], s35 offen offset:1024 sc1 lds
    buffer_load_dwordx4 v2, s[20:23], s35 offen offset:2048 sc1 lds
    s_branch L_f_a2
L_f_a1:
    s_lshl_b32 s32, s26, 8
    s_lshl_b32 s33, s44, 6
    s_add_u32 s32, s32, s33
    s_add_u32 s32, s32, 29097984
    s_lshl_b32 s34, s26, 2
    s_add_u32 s34, s34, s44
    s_lshl_b32 s34, s34, 14
    s_add_u32 s34, s34, 6291456
    s_lshl_b32 s33, s44, 14
    s_add_u32 m0, s33, 86016
    s_mov_b32 s36, 0
L_poll_fa:
    buffer_load_dword v232, v229, s[20:23], s32 offen sc1
    s_add_u32 s36, s36, 1
    s_waitcnt vmcnt(0)
    v_cmp_ne_u32 vcc, 0, v232
    s_cmp_gt_u32 s36, 0x40000
    s_cbranch_scc1 L_polld_fa
    s_and_b32 s37, vcc_lo, 0xffff
    s_cmp_lg_u32 s37, 0xffff
    s_cbranch_scc1 L_poll_fa
L_polld_fa:
    buffer_load_dwordx4 v2, s[20:23], s34 offen offset:0 sc1 lds
    buffer_load_dwordx4 v2, s[20:23], s34 offen offset:1024 sc1 lds
    buffer_load_dwordx4 v2, s[20:23], s34 offen offset:2048 sc1 lds
    buffer_load_dwordx4 v2, s[20:23], s34 offen offset:3072 sc1 lds
    s_add_u32 m0, m0, 4096
    s_add_u32 s34, s34, 4096
    buffer_load_dwordx4 v2, s[20:23], s34 offen offset:0 sc1 lds
    buffer_load_dwordx4 v2, s[20:23], s34 offen offset:1024 sc1 lds
    buffer_load_dwordx4 v2, s[20:23], s34 offen offset:2048 sc1 lds
    buffer_load_dwordx4 v2, s[20:23], s34 offen offset:3072 sc1 lds
    s_add_u32 m0, m0, 4096
    s_add_u32 s34, s34, 4096
    buffer_load_dwordx4 v2, s[20:23], s34 offen offset:0 sc1 lds
    buffer_load_dwordx4 v2, s[20:23], s34 offen offset:1024 sc1 lds
    buffer_load_dwordx4 v2, s[20:23], s34 offen offset:2048 sc1 lds
    buffer_load_dwordx4 v2, s[20:23], s34 offen offset:3072 sc1 lds
    s_add_u32 m0, m0, 4096
    s_add_u32 s34, s34, 4096
    buffer_load_dwordx4 v2, s[20:23], s34 offen offset:0 sc1 lds
    buffer_load_dwordx4 v2, s[20:23], s34 offen offset:1024 sc1 lds
    buffer_load_dwordx4 v2, s[20:23], s34 offen offset:2048 sc1 lds
    buffer_load_dwordx4 v2, s[20:23], s34 offen offset:3072 sc1 lds
L_f_a2:
    s_bfe_u32 s33, s40, 0x10001
    s_lshl_b32 s33, s33, 1
    s_add_u32 s33, s33, s31
    s_lshl_b32 s33, s33, 14
    s_add_u32 s33, s33, 86016
    v_add_u32 v12, s33, v2
    s_lshl_b32 s33, s44, 14
    s_add_u32 s33, s33, 86016
    s_lshl_b32 s37, s31, 11
    s_add_u32 s33, s33, s37
    v_add_u32 v14, s33, v2
    v_xor_b32 v13, 0x800, v14
    v_lshlrev_b32 v80, 16, v224
    v_and_b32 v81, s43, v224
    v_lshlrev_b32 v82, 16, v225
    v_and_b32 v83, s43, v225
    v_lshlrev_b32 v84, 16, v226
    v_and_b32 v85, s43, v226
    v_lshlrev_b32 v86, 16, v227
    v_and_b32 v87, s43, v227
    s_cmp_lt_u32 s40, 4
    s_cbranch_scc1 L_f_b30
    s_waitcnt vmcnt(8)
L_f_b30:
    s_barrier
    ds_read_b128 v[16:19], v12 offset:0
    ds_read_b128 v[20:23], v12 offset:1024
    ds_read_b128 v[24:27], v12 offset:2048
    ds_read_b128 v[28:31], v12 offset:3072
    ds_read_b128 v[32:35], v12 offset:4096
    ds_read_b128 v[36:39], v12 offset:5120
    ds_read_b128 v[40:43], v12 offset:6144
    ds_read_b128 v[44:47], v12 offset:7168
    s_waitcnt lgkmcnt(7)
    v_mfma_f32_32x32x16_bf16 v[64:79], v[160:163], v[16:19], 0
    s_waitcnt lgkmcnt(6)
    v_mfma_f32_32x32x16_bf16 v[64:79], v[164:167], v[20:23], v[64:79]
    s_waitcnt lgkmcnt(5)
    v_mfma_f32_32x32x16_bf16 v[64:79], v[168:171], v[24:27], v[64:79]
    s_waitcnt lgkmcnt(4)
    v_mfma_f32_32x32x16_bf16 v[64:79], v[172:175], v[28:31], v[64:79]
    s_waitcnt lgkmcnt(0)
    s_cmp_lt_u32 s40, 4
    s_cbranch_scc1 L_f_b31
    s_waitcnt vmcnt(0)
L_f_b31:
    s_barrier
    ds_read_b128 v[96:99], v12 offset:8192
    ds_read_b128 v[100:103], v12 offset:9216
    ds_read_b128 v[104:107], v12 offset:10240
    ds_read_b128 v[108:111], v12 offset:11264
    ds_read_b128 v[112:115], v12 offset:12288
    ds_read_b128 v[116:119], v12 offset:13312
    ds_read_b128 v[120:123], v12 offset:14336
    ds_read_b128 v[124:127], v12 offset:15360
    v_mfma_f32_32x32x16_bf16 v[64:79], v[176:179], v[32:35], v[64:79]
    v_mfma_f32_32x32x16_bf16 v[64:79], v[180:183], v[36:39], v[64:79]
    v_mfma_f32_32x32x16_bf16 v[64:79], v[184:187], v[40:43], v[64:79]
    v_mfma_f32_32x32x16_bf16 v[64:79], v[188:191], v[44:47], v[64:79]
    s_waitcnt lgkmcnt(7)
    v_mfma_f32_32x32x16_bf16 v[64:79], v[192:195], v[96:99], v[64:79]
    s_waitcnt lgkmcnt(6)
    v_mfma_f32_32x32x16_bf16 v[64:79], v[196:199], v[100:103], v[64:79]
    s_waitcnt lgkmcnt(5)
    v_mfma_f32_32x32x16_bf16 v[64:79], v[200:203], v[104:107], v[64:79]
    s_waitcnt lgkmcnt(4)
    v_mfma_f32_32x32x16_bf16 v[64:79], v[204:207], v[108:111], v[64:79]
    s_waitcnt lgkmcnt(3)
    v_mfma_f32_32x32x16_bf16 v[64:79], v[208:211], v[112:115], v[64:79]
    s_waitcnt lgkmcnt(2)
    v_mfma_f32_32x32x16_bf16 v[64:79], v[212:215], v[116:119], v[64:79]
    s_waitcnt lgkmcnt(1)
    v_mfma_f32_32x32x16_bf16 v[64:79], v[216:219], v[120:123], v[64:79]
    s_waitcnt lgkmcnt(0)
    v_mfma_f32_32x32x16_bf16 v[64:79], v[220:223], v[124:127], v[64:79]
    s_lshl_b32 s32, s29, 4
    s_add_u32 s32, s32, s30
    s_lshl_b32 s32, s32, 1
    s_add_u32 s32, s32, s31
    s_lshr_b32 s33, s32, 1
    s_lshl_b32 s33, s33, 9
    s_lshl_b32 s34, s31, 3
    s_add_u32 s33, s33, s34
    s_add_u32 s33, s33, 26214400
    s_lshl_b32 s32, s32, 10
    s_add_u32 s32, s32, 8388608
    v_and_b32 v3, 31, v1
    v_lshlrev_b32 v3, 4, v3
    s_nop 1
    ds_write_b128 v13, v[72:75] offset:0
    ds_write_b128 v13, v[76:79] offset:1024
    v_add_f32 v64, v64, v80
    v_add_f32 v65, v65, v81
    v_add_f32 v66, v66, v82
    v_add_f32 v67, v67, v83
    v_add_f32 v68, v68, v84
    v_add_f32 v69, v69, v85
    v_add_f32 v70, v70, v86
    v_add_f32 v71, v71, v87
    s_waitcnt lgkmcnt(0)
    s_barrier
    ds_read_b128 v[80:83], v14 offset:0
    ds_read_b128 v[84:87], v14 offset:1024
    s_waitcnt lgkmcnt(0)
    v_add_f32 v64, v64, v80
    v_add_f32 v65, v65, v81
    v_add_f32 v66, v66, v82
    v_add_f32 v67, v67, v83
    v_add_f32 v68, v68, v84
    v_add_f32 v69, v69, v85
    v_add_f32 v70, v70, v86
    v_add_f32 v71, v71, v87
    v_cvt_pk_bf16_f32 v16, v64, v65
    v_cvt_pk_bf16_f32 v17, v66, v67
    v_cvt_pk_bf16_f32 v18, v68, v69
    v_cvt_pk_bf16_f32 v19, v70, v71
    s_cmp_eq_u32 s63, -1
    s_cbranch_scc1 L_hs_h_f
    buffer_store_dwordx4 v[16:19], v2, s[20:23], s32 offen sc1
    s_branch L_hs_h_d
L_hs_h_f:
    buffer_store_dwordx4 v[16:19], v2, s[20:23], s32 offen
L_hs_h_d:
    v_lshlrev_b32 v80, 16, v16
    v_and_b32 v81, s43, v16
    v_lshlrev_b32 v82, 16, v17
    v_and_b32 v83, s43, v17
    v_lshlrev_b32 v84, 16, v18
    v_and_b32 v85, s43, v18
    v_lshlrev_b32 v86, 16, v19
    v_and_b32 v87, s43, v19
    v_add_f32 v64, v80, v81
    v_mul_f32 v65, v80, v80
    v_fmac_f32 v65, v81, v81
    v_add_f32 v64, v64, v82
    v_fmac_f32 v65, v82, v82
    v_add_f32 v64, v64, v83
    v_fmac_f32 v65, v83, v83
    v_add_f32 v64, v64, v84
    v_fmac_f32 v65, v84, v84
    v_add_f32 v64, v64, v85
    v_fmac_f32 v65, v85, v85
    v_add_f32 v64, v64, v86
    v_fmac_f32 v65, v86, v86
    v_add_f32 v64, v64, v87
    v_fmac_f32 v65, v87, v87
    v_mov_b32 v66, v64
    s_nop 1
    v_permlane32_swap_b32 v64, v66
    s_nop 1
    v_add_f32 v64, v64, v66
    v_mov_b32 v67, v65
    s_nop 1
    v_permlane32_swap_b32 v65, v67
    s_nop 1
    v_add_f32 v65, v65, v67
    s_cmp_eq_u32 s63, -1
    s_cbranch_scc1 L_hs_st_f
    buffer_store_dwordx2 v[64:65], v3, s[20:23], s33 offen sc1
    s_branch L_hs_st_d
L_hs_st_f:
    buffer_store_dwordx2 v[64:65], v3, s[20:23], s33 offen
L_hs_st_d:
    s_lshl_b32 s33, s29, 4
    s_add_u32 s33, s33, s30
    s_lshl_b32 s33, s33, 1
    s_add_u32 s33, s33, s31
    s_lshl_b32 s33, s33, 2
    s_add_u32 s33, s33, 29106176
    v_mov_b32 v14, v228
    v_mov_b32 v15, v229
    s_waitcnt vmcnt(0)
    v_mov_b32 v3, 0
    v_mov_b32 v4, 1
    s_mov_b64 exec, 1
    s_cmp_eq_u32 s63, -1
    s_cbranch_scc1 L_hs_fb_f
    buffer_store_dword v4, v3, s[20:23], s33 offen sc1
    s_branch L_hs_fb_d
L_hs_fb_f:
    buffer_store_dword v4, v3, s[20:23], s33 offen
L_hs_fb_d:
    s_mov_b64 exec, -1
    s_cmp_ge_u32 s40, 4
    s_cbranch_scc1 L_f_b5
    s_add_u32 s34, s46, 57344
    s_add_u32 m0, s45, 57344
    s_add_u32 s35, s34, 4096
    buffer_load_dwordx4 v2, s[20:23], s34 offen offset:0 sc1 lds
    buffer_load_dwordx4 v2, s[20:23], s34 offen offset:1024 sc1 lds
    buffer_load_dwordx4 v2, s[20:23], s34 offen offset:2048 sc1 lds
    buffer_load_dwordx4 v2, s[20:23], s34 offen offset:3072 sc1 lds
    s_add_u32 m0, m0, 4096
    s_nop 0
    buffer_load_dwordx4 v2, s[20:23], s35 offen offset:0 sc1 lds
    buffer_load_dwordx4 v2, s[20:23], s35 offen offset:1024 sc1 lds
    buffer_load_dwordx4 v2, s[20:23], s35 offen offset:2048 sc1 lds
L_f_b5:
    s_barrier
    s_lshl_b32 s32, s27, 2
    s_add_u32 s32, s32, s44
    s_lshl_b32 s47, s32, 15
    s_add_u32 s47, s47, 8388608
    s_lshl_b32 s48, s44, 12
    s_add_u32 s48, s48, 114688
    s_cmp_ge_u32 s40, 4
    s_cbranch_scc1 L_f_ccomp
    s_add_u32 s34, s46, 86016
    s_add_u32 m0, s45, 86016
    s_add_u32 s35, s34, 4096
    buffer_load_dwordx4 v2, s[20:23], s34 offen offset:0 sc1 lds
    buffer_load_dwordx4 v2, s[20:23], s34 offen offset:1024 sc1 lds
    buffer_load_dwordx4 v2, s[20:23], s34 offen offset:2048 sc1 lds
    buffer_load_dwordx4 v2, s[20:23], s34 offen offset:3072 sc1 lds
    s_add_u32 m0, m0, 4096
    s_nop 0
    buffer_load_dwordx4 v2, s[20:23], s35 offen offset:0 sc1 lds
    buffer_load_dwordx4 v2, s[20:23], s35 offen offset:1024 sc1 lds
    buffer_load_dwordx4 v2, s[20:23], s35 offen offset:2048 sc1 lds
    s_lshr_b32 s50, s40, 1
    s_lshl_b32 s32, s30, 2
    s_add_u32 s32, s32, s50
    s_mul_i32 s32, s32, 28672
    s_add_u32 s32, s32, 18874368
    s_add_u32 s33, s32, 57344
    v_xor_b32 v3, 0x100, v2
    s_mul_i32 s37, s44, 28672
    v_add_u32 v4, s37, v2
    s_waitcnt vmcnt(21)
    s_barrier
    s_waitcnt vmcnt(14)
    s_barrier
    s_add_u32 m0, s48, 0
    s_add_u32 s34, s47, 12288
    buffer_load_dwordx4 v2, s[20:23], s34 offen offset:0 sc1 lds
    buffer_load_dwordx4 v2, s[20:23], s34 offen offset:1024 sc1 lds
    buffer_load_dwordx4 v2, s[20:23], s34 offen offset:2048 sc1 lds
    buffer_load_dwordx4 v2, s[20:23], s34 offen offset:3072 sc1 lds
    s_add_u32 s34, s46, 114688
    s_add_u32 m0, s45, 0
    s_add_u32 s35, s34, 4096
    buffer_load_dwordx4 v2, s[20:23], s34 offen offset:0 sc1 lds
    buffer_load_dwordx4 v2, s[20:23], s34 offen offset:1024 sc1 lds
    buffer_load_dwordx4 v2, s[20:23], s34 offen offset:2048 sc1 lds
    buffer_load_dwordx4 v2, s[20:23], s34 offen offset:3072 sc1 lds
    s_add_u32 m0, m0, 4096
    s_nop 0
    buffer_load_dwordx4 v2, s[20:23], s35 offen offset:0 sc1 lds
    buffer_load_dwordx4 v2, s[20:23], s35 offen offset:1024 sc1 lds
    buffer_load_dwordx4 v2, s[20:23], s35 offen offset:2048 sc1 lds
    s_waitcnt vmcnt(18)
    s_barrier
    s_add_u32 m0, s48, 16384
    s_add_u32 s34, s47, 16384
    buffer_load_dwordx4 v2, s[20:23], s34 offen offset:0 sc1 lds
    buffer_load_dwordx4 v2, s[20:23], s34 offen offset:1024 sc1 lds
    buffer_load_dwordx4 v2, s[20:23], s34 offen offset:2048 sc1 lds
    buffer_load_dwordx4 v2, s[20:23], s34 offen offset:3072 sc1 lds
    s_add_u32 s34, s46, 143360
    s_add_u32 m0, s45, 28672
    s_add_u32 s35, s34, 4096
    buffer_load_dwordx4 v2, s[20:23], s34 offen offset:0 sc1 lds
    buffer_load_dwordx4 v2, s[20:23], s34 offen offset:1024 sc1 lds
    buffer_load_dwordx4 v2, s[20:23], s34 offen offset:2048 sc1 lds
    buffer_load_dwordx4 v2, s[20:23], s34 offen offset:3072 sc1 lds
    s_add_u32 m0, m0, 4096
    s_nop 0
    buffer_load_dwordx4 v2, s[20:23], s35 offen offset:0 sc1 lds
    buffer_load_dwordx4 v2, s[20:23], s35 offen offset:1024 sc1 lds
    buffer_load_dwordx4 v2, s[20:23], s35 offen offset:2048 sc1 lds
    s_waitcnt vmcnt(18)
    s_barrier
    s_add_u32 m0, s48, 32768
    s_add_u32 s34, s47, 20480
    buffer_load_dwordx4 v2, s[20:23], s34 offen offset:0 sc1 lds
    buffer_load_dwordx4 v2, s[20:23], s34 offen offset:1024 sc1 lds
    buffer_load_dwordx4 v2, s[20:23], s34 offen offset:2048 sc1 lds
    buffer_load_dwordx4 v2, s[20:23], s34 offen offset:3072 sc1 lds
    s_add_u32 s34, s46, 172032
    s_add_u32 m0, s45, 57344
    s_add_u32 s35, s34, 4096
    buffer_load_dwordx4 v2, s[20:23], s34 offen offset:0 sc1 lds
    buffer_load_dwordx4 v2, s[20:23], s34 offen offset:1024 sc1 lds
    buffer_load_dwordx4 v2, s[20:23], s34 offen offset:2048 sc1 lds
    buffer_load_dwordx4 v2, s[20:23], s34 offen offset:3072 sc1 lds
    s_add_u32 m0, m0, 4096
    s_nop 0
    buffer_load_dwordx4 v2, s[20:23], s35 offen offset:0 sc1 lds
    buffer_load_dwordx4 v2, s[20:23], s35 offen offset:1024 sc1 lds
    buffer_load_dwordx4 v2, s[20:23], s35 offen offset:2048 sc1 lds
    s_waitcnt vmcnt(18)
    s_barrier
    s_add_u32 m0, s48, 0
    s_add_u32 s34, s47, 24576
    buffer_load_dwordx4 v2, s[20:23], s34 offen offset:0 sc1 lds
    buffer_load_dwordx4 v2, s[20:23], s34 offen offset:1024 sc1 lds
    buffer_load_dwordx4 v2, s[20:23], s34 offen offset:2048 sc1 lds
    buffer_load_dwordx4 v2, s[20:23], s34 offen offset:3072 sc1 lds
    s_add_u32 s34, s46, 200704
    s_add_u32 m0, s45, 86016
    s_add_u32 s35, s34, 4096
    buffer_load_dwordx4 v2, s[20:23], s34 offen offset:0 sc1 lds
    buffer_load_dwordx4 v2, s[20:23], s34 offen offset:1024 sc1 lds
    buffer_load_dwordx4 v2, s[20:23], s34 offen offset:2048 sc1 lds
    buffer_load_dwordx4 v2, s[20:23], s34 offen offset:3072 sc1 lds
    s_add_u32 m0, m0, 4096
    s_nop 0
    buffer_load_dwordx4 v2, s[20:23], s35 offen offset:0 sc1 lds
    buffer_load_dwordx4 v2, s[20:23], s35 offen offset:1024 sc1 lds
    buffer_load_dwordx4 v2, s[20:23], s35 offen offset:2048 sc1 lds
    s_waitcnt vmcnt(18)
    s_barrier
    s_add_u32 m0, s48, 16384
    s_add_u32 s34, s47, 28672
    buffer_load_dwordx4 v2, s[20:23], s34 offen offset:0 sc1 lds
    buffer_load_dwordx4 v2, s[20:23], s34 offen offset:1024 sc1 lds
    buffer_load_dwordx4 v2, s[20:23], s34 offen offset:2048 sc1 lds
    buffer_load_dwordx4 v2, s[20:23], s34 offen offset:3072 sc1 lds
    buffer_load_dwordx4 v[144:147], v14, s[20:23], s32 offen offset:0 sc1
    buffer_load_dwordx4 v[148:151], v14, s[20:23], s32 offen offset:1024 sc1
    buffer_load_dwordx4 v[152:155], v14, s[20:23], s32 offen offset:2048 sc1
    buffer_load_dwordx4 v[156:159], v14, s[20:23], s32 offen offset:3072 sc1
    s_add_u32 s32, s32, 4096
    buffer_load_dwordx4 v[160:163], v14, s[20:23], s32 offen offset:0 sc1
    buffer_load_dwordx4 v[164:167], v14, s[20:23], s32 offen offset:1024 sc1
    buffer_load_dwordx4 v[168:171], v14, s[20:23], s32 offen offset:2048 sc1
    buffer_load_dwordx4 v[172:175], v14, s[20:23], s32 offen offset:3072 sc1
    s_waitcnt vmcnt(19)
    s_barrier
    s_add_u32 s32, s32, 4096
    buffer_load_dwordx4 v[176:179], v14, s[20:23], s32 offen offset:0 sc1
    buffer_load_dwordx4 v[180:183], v14, s[20:23], s32 offen offset:1024 sc1
    buffer_load_dwordx4 v[184:187], v14, s[20:23], s32 offen offset:2048 sc1
    buffer_load_dwordx4 v[188:191], v14, s[20:23], s32 offen offset:3072 sc1
    s_add_u32 s32, s32, 4096
    buffer_load_dwordx4 v[192:195], v14, s[20:23], s32 offen offset:0 sc1
    buffer_load_dwordx4 v[196:199], v14, s[20:23], s32 offen offset:1024 sc1
    buffer_load_dwordx4 v[200:203], v14, s[20:23], s32 offen offset:2048 sc1
    buffer_load_dwordx4 v[204:207], v14, s[20:23], s32 offen offset:3072 sc1
    s_add_u32 s32, s32, 4096
    buffer_load_dwordx4 v[208:211], v14, s[20:23], s32 offen offset:0 sc1
    buffer_load_dwordx4 v[212:215], v14, s[20:23], s32 offen offset:1024 sc1
    buffer_load_dwordx4 v[216:219], v14, s[20:23], s32 offen offset:2048 sc1
    buffer_load_dwordx4 v[220:223], v14, s[20:23], s32 offen offset:3072 sc1
    s_waitcnt vmcnt(20)
    s_barrier
    s_add_u32 s32, s32, 4096
    buffer_load_dwordx4 v[224:227], v14, s[20:23], s32 offen offset:0 sc1
    buffer_load_dwordx4 v[228:231], v14, s[20:23], s32 offen offset:1024 sc1
    buffer_load_dwordx4 v[232:235], v14, s[20:23], s32 offen offset:2048 sc1
    buffer_load_dwordx4 v[236:239], v14, s[20:23], s32 offen offset:3072 sc1
    s_add_u32 s32, s32, 4096
    buffer_load_dwordx4 v[240:243], v14, s[20:23], s32 offen offset:0 sc1
    buffer_load_dwordx4 v[244:247], v14, s[20:23], s32 offen offset:1024 sc1
    buffer_load_dwordx4 v[248:251], v14, s[20:23], s32 offen offset:2048 sc1
    buffer_load_dwordx4 v[252:255], v14, s[20:23], s32 offen offset:3072 sc1
    s_mov_b32 m0, s37
    s_barrier
    buffer_load_dwordx4 v3, s[20:23], s33 offen offset:0 sc1 lds
    buffer_load_dwordx4 v3, s[20:23], s33 offen offset:1024 sc1 lds
    buffer_load_dwordx4 v3, s[20:23], s33 offen offset:2048 sc1 lds
    buffer_load_dwordx4 v3, s[20:23], s33 offen offset:3072 sc1 lds
    s_add_u32 m0, m0, 4096
    s_add_u32 s33, s33, 4096
    buffer_load_dwordx4 v3, s[20:23], s33 offen offset:0 sc1 lds
    buffer_load_dwordx4 v3, s[20:23], s33 offen offset:1024 sc1 lds
    buffer_load_dwordx4 v3, s[20:23], s33 offen offset:2048 sc1 lds
    buffer_load_dwordx4 v3, s[20:23], s33 offen offset:3072 sc1 lds
    s_add_u32 m0, m0, 4096
    s_add_u32 s33, s33, 4096
    buffer_load_dwordx4 v3, s[20:23], s33 offen offset:0 sc1 lds
    buffer_load_dwordx4 v3, s[20:23], s33 offen offset:1024 sc1 lds
    buffer_load_dwordx4 v3, s[20:23], s33 offen offset:2048 sc1 lds
    buffer_load_dwordx4 v3, s[20:23], s33 offen offset:3072 sc1 lds
    s_add_u32 m0, m0, 4096
    s_add_u32 s33, s33, 4096
    buffer_load_dwordx4 v3, s[20:23], s33 offen offset:0 sc1 lds
    buffer_load_dwordx4 v3, s[20:23], s33 offen offset:1024 sc1 lds
    buffer_load_dwordx4 v3, s[20:23], s33 offen offset:2048 sc1 lds
    buffer_load_dwordx4 v3, s[20:23], s33 offen offset:3072 sc1 lds
    s_add_u32 m0, m0, 4096
    s_add_u32 s33, s33, 4096
    buffer_load_dwordx4 v3, s[20:23], s33 offen offset:0 sc1 lds
    buffer_load_dwordx4 v3, s[20:23], s33 offen offset:1024 sc1 lds
    buffer_load_dwordx4 v3, s[20:23], s33 offen offset:2048 sc1 lds
    buffer_load_dwordx4 v3, s[20:23], s33 offen offset:3072 sc1 lds
    s_add_u32 m0, m0, 4096
    s_add_u32 s33, s33, 4096
    buffer_load_dwordx4 v3, s[20:23], s33 offen offset:0 sc1 lds
    buffer_load_dwordx4 v3, s[20:23], s33 offen offset:1024 sc1 lds
    buffer_load_dwordx4 v3, s[20:23], s33 offen offset:2048 sc1 lds
    buffer_load_dwordx4 v3, s[20:23], s33 offen offset:3072 sc1 lds
    s_add_u32 m0, m0, 4096
    s_add_u32 s33, s33, 4096
    buffer_load_dwordx4 v3, s[20:23], s33 offen offset:0 sc1 lds
    buffer_load_dwordx4 v3, s[20:23], s33 offen offset:1024 sc1 lds
    buffer_load_dwordx4 v3, s[20:23], s33 offen offset:2048 sc1 lds
    buffer_load_dwordx4 v3, s[20:23], s33 offen offset:3072 sc1 lds
    s_waitcnt vmcnt(0)
    s_barrier
    s_branch L_f_d1
L_f_ccomp:
    s_setprio 2
    s_lshl_b32 s49, s27, 2
    s_add_u32 s49, s49, s44
    v_mov_b32 v12, v2
    s_lshl_b32 s32, s44, 12
    s_add_u32 s32, s32, 114688
    v_add_u32 v13, s32, v2
    v_and_b32 v3, 31, v1
    v_lshlrev_b32 v3, 4, v3
    v_lshrrev_b32 v4, 5, v1
    v_lshl_add_u32 v3, v4, 12, v3
    s_mul_i32 s34, s28, 7168
    s_add_u32 s34, s34, 25165824
    s_add_u32 s35, s34, 4096
    buffer_load_dwordx4 v[52:55], v2, s[20:23], s34 offen offset:0 sc1
    buffer_load_dwordx4 v[56:59], v2, s[20:23], s34 offen offset:1024 sc1
    buffer_load_dwordx4 v[60:63], v2, s[20:23], s34 offen offset:2048 sc1
    buffer_load_dwordx4 v[64:67], v2, s[20:23], s34 offen offset:3072 sc1
    buffer_load_dwordx4 v[68:71], v2, s[20:23], s35 offen offset:0 sc1
    buffer_load_dwordx4 v[72:75], v2, s[20:23], s35 offen offset:1024 sc1
    buffer_load_dwordx4 v[76:79], v2, s[20:23], s35 offen offset:2048 sc1
    s_lshl_b32 s33, s49, 7
    s_add_u32 s33, s33, 29106176
    s_mov_b32 s36, 0
L_poll_fb:
    buffer_load_dword v9, v15, s[20:23], s33 offen sc1
    s_add_u32 s36, s36, 1
    s_waitcnt vmcnt(0)
    v_cmp_ne_u32 vcc, 0, v9
    s_cmp_gt_u32 s36, 0x40000
    s_cbranch_scc1 L_polld_fb
    s_and_b32 s37, vcc_lo, 0xffffffff
    s_cmp_lg_u32 s37, 0xffffffff
    s_cbranch_scc1 L_poll_fb
L_polld_fb:
    s_add_u32 m0, s48, 0
    s_add_u32 s34, s47, 0
    buffer_load_dwordx4 v2, s[20:23], s34 offen offset:0 sc1 lds
    buffer_load_dwordx4 v2, s[20:23], s34 offen offset:1024 sc1 lds
    buffer_load_dwordx4 v2, s[20:23], s34 offen offset:2048 sc1 lds
    buffer_load_dwordx4 v2, s[20:23], s34 offen offset:3072 sc1 lds
    s_add_u32 m0, s48, 16384
    s_add_u32 s34, s47, 4096
    buffer_load_dwordx4 v2, s[20:23], s34 offen offset:0 sc1 lds
    buffer_load_dwordx4 v2, s[20:23], s34 offen offset:1024 sc1 lds
    buffer_load_dwordx4 v2, s[20:23], s34 offen offset:2048 sc1 lds
    buffer_load_dwordx4 v2, s[20:23], s34 offen offset:3072 sc1 lds
    s_add_u32 m0, s48, 32768
    s_add_u32 s34, s47, 8192
    buffer_load_dwordx4 v2, s[20:23], s34 offen offset:0 sc1 lds
    buffer_load_dwordx4 v2, s[20:23], s34 offen offset:1024 sc1 lds
    buffer_load_dwordx4 v2, s[20:23], s34 offen offset:2048 sc1 lds
    buffer_load_dwordx4 v2, s[20:23], s34 offen offset:3072 sc1 lds
    s_lshl_b32 s32, s49, 13
    s_add_u32 s32, s32, 26214400
    v_add_f32 v52, v52, v53
    v_add_f32 v54, v54, v55
    v_add_f32 v5, v52, v54
    v_cvt_pk_bf16_f32 v4, v5, v5
    v_and_b32 v4, s43, v4
    v_sub_f32 v4, v5, v4
    v_cvt_pk_bf16_f32 v52, v5, v4
    v_mov_b32 v53, v52
    v_mov_b32 v54, 0
    v_mov_b32 v55, 0
    v_add_f32 v56, v56, v57
    v_add_f32 v58, v58, v59
    v_add_f32 v5, v56, v58
    v_cvt_pk_bf16_f32 v4, v5, v5
    v_and_b32 v4, s43, v4
    v_sub_f32 v4, v5, v4
    v_cvt_pk_bf16_f32 v56, v5, v4
    v_mov_b32 v57, v56
    v_mov_b32 v58, 0
    v_mov_b32 v59, 0
    v_add_f32 v60, v60, v61
    v_add_f32 v62, v62, v63
    v_add_f32 v5, v60, v62
    v_cvt_pk_bf16_f32 v4, v5, v5
    v_and_b32 v4, s43, v4
    v_sub_f32 v4, v5, v4
    v_cvt_pk_bf16_f32 v60, v5, v4
    v_mov_b32 v61, v60
    v_mov_b32 v62, 0
    v_mov_b32 v63, 0
    v_add_f32 v64, v64, v65
    v_add_f32 v66, v66, v67
    v_add_f32 v5, v64, v66
    v_cvt_pk_bf16_f32 v4, v5, v5
    v_and_b32 v4, s43, v4
    v_sub_f32 v4, v5, v4
    v_cvt_pk_bf16_f32 v64, v5, v4
    v_mov_b32 v65, v64
    v_mov_b32 v66, 0
    v_mov_b32 v67, 0
    v_add_f32 v68, v68, v69
    v_add_f32 v70, v70, v71
    v_add_f32 v5, v68, v70
    v_cvt_pk_bf16_f32 v4, v5, v5
    v_and_b32 v4, s43, v4
    v_sub_f32 v4, v5, v4
    v_cvt_pk_bf16_f32 v68, v5, v4
    v_mov_b32 v69, v68
    v_mov_b32 v70, 0
    v_mov_b32 v71, 0
    v_add_f32 v72, v72, v73
    v_add_f32 v74, v74, v75
    v_add_f32 v5, v72, v74
    v_cvt_pk_bf16_f32 v4, v5, v5
    v_and_b32 v4, s43, v4
    v_sub_f32 v4, v5, v4
    v_cvt_pk_bf16_f32 v72, v5, v4
    v_mov_b32 v73, v72
    v_mov_b32 v74, 0
    v_mov_b32 v75, 0
    v_add_f32 v76, v76, v77
    v_add_f32 v78, v78, v79
    v_add_f32 v5, v76, v78
    v_cvt_pk_bf16_f32 v4, v5, v5
    v_and_b32 v4, s43, v4
    v_sub_f32 v4, v5, v4
    v_cvt_pk_bf16_f32 v76, v5, v4
    v_mov_b32 v77, v76
    v_mov_b32 v78, 0
    v_mov_b32 v79, 0
    s_waitcnt vmcnt(8)
    s_barrier
    ds_read_b128 v[80:83], v13 offset:0
    ds_read_b128 v[88:91], v12 offset:0
    ds_read_b128 v[92:95], v12 offset:1024
    ds_read_b128 v[96:99], v12 offset:2048
    ds_read_b128 v[100:103], v12 offset:3072
    ds_read_b128 v[104:107], v12 offset:4096
    ds_read_b128 v[108:111], v12 offset:5120
    ds_read_b128 v[112:115], v12 offset:6144
    s_waitcnt lgkmcnt(6)
    v_mfma_f32_32x32x16_bf16 v[144:159], v[88:91], v[80:83], 0
    ds_read_b128 v[84:87], v13 offset:1024
    ds_read_b128 v[116:119], v12 offset:7168
    buffer_load_dwordx4 v[20:23], v3, s[20:23], s32 offen offset:0 sc1
    buffer_load_dwordx4 v[24:27], v3, s[20:23], s32 offen offset:512 sc1
    s_waitcnt lgkmcnt(7)
    v_mfma_f32_32x32x16_bf16 v[160:175], v[92:95], v[80:83], 0
    ds_read_b128 v[120:123], v12 offset:8192
    ds_read_b128 v[124:127], v12 offset:9216
    buffer_load_dwordx4 v[28:31], v3, s[20:23], s32 offen offset:1024 sc1
    buffer_load_dwordx4 v[32:35], v3, s[20:23], s32 offen offset:1536 sc1
    s_waitcnt lgkmcnt(8)
    v_mfma_f32_32x32x16_bf16 v[176:191], v[96:99], v[80:83], 0
    ds_read_b128 v[128:131], v12 offset:10240
    ds_read_b128 v[132:135], v12 offset:11264
    s_waitcnt lgkmcnt(9)
    v_mfma_f32_32x32x16_bf16 v[192:207], v[100:103], v[80:83], 0
    ds_read_b128 v[136:139], v12 offset:12288
    ds_read_b128 v[140:143], v12 offset:13312
    s_waitcnt lgkmcnt(10)
    v_mfma_f32_32x32x16_bf16 v[208:223], v[104:107], v[80:83], 0
    s_waitcnt lgkmcnt(9)
    v_mfma_f32_32x32x16_bf16 v[224:239], v[108:111], v[80:83], 0
    s_waitcnt lgkmcnt(8)
    v_mfma_f32_32x32x16_bf16 v[240:255], v[112:115], v[80:83], 0
    s_waitcnt lgkmcnt(6)
    v_mfma_f32_32x32x16_bf16 v[144:159], v[116:119], v[84:87], v[144:159]
    ds_read_b128 v[80:83], v13 offset:2048
    ds_read_b128 v[88:91], v12 offset:14336
    buffer_load_dwordx4 v[36:39], v3, s[20:23], s32 offen offset:2048 sc1
    buffer_load_dwordx4 v[40:43], v3, s[20:23], s32 offen offset:2560 sc1
    s_waitcnt lgkmcnt(7)
    v_mfma_f32_32x32x16_bf16 v[160:175], v[120:123], v[84:87], v[160:175]
    ds_read_b128 v[92:95], v12 offset:15360
    ds_read_b128 v[96:99], v12 offset:16384
    buffer_load_dwordx4 v[44:47], v3, s[20:23], s32 offen offset:3072 sc1
    buffer_load_dwordx4 v[48:51], v3, s[20:23], s32 offen offset:3584 sc1
    s_waitcnt lgkmcnt(8)
    v_mfma_f32_32x32x16_bf16 v[176:191], v[124:127], v[84:87], v[176:191]
    ds_read_b128 v[100:103], v12 offset:17408
    ds_read_b128 v[104:107], v12 offset:18432
    s_waitcnt lgkmcnt(9)
    v_mfma_f32_32x32x16_bf16 v[192:207], v[128:131], v[84:87], v[192:207]
    ds_read_b128 v[108:111], v12 offset:19456
    ds_read_b128 v[112:115], v12 offset:20480
    s_waitcnt lgkmcnt(10)
    v_mfma_f32_32x32x16_bf16 v[208:223], v[132:135], v[84:87], v[208:223]
    s_waitcnt lgkmcnt(9)
    v_mfma_f32_32x32x16_bf16 v[224:239], v[136:139], v[84:87], v[224:239]
    s_waitcnt lgkmcnt(8)
    v_mfma_f32_32x32x16_bf16 v[240:255], v[140:143], v[84:87], v[240:255]
    s_waitcnt lgkmcnt(6)
    v_mfma_f32_32x32x16_bf16 v[144:159], v[88:91], v[80:83], v[144:159]
    ds_read_b128 v[84:87], v13 offset:3072
    ds_read_b128 v[116:119], v12 offset:21504
    s_waitcnt lgkmcnt(7)
    v_mfma_f32_32x32x16_bf16 v[160:175], v[92:95], v[80:83], v[160:175]
    ds_read_b128 v[120:123], v12 offset:22528
    ds_read_b128 v[124:127], v12 offset:23552
    s_waitcnt lgkmcnt(8)
    v_mfma_f32_32x32x16_bf16 v[176:191], v[96:99], v[80:83], v[176:191]
    ds_read_b128 v[128:131], v12 offset:24576
    ds_read_b128 v[132:135], v12 offset:25600
    s_waitcnt lgkmcnt(9)
    v_mfma_f32_32x32x16_bf16 v[192:207], v[100:103], v[80:83], v[192:207]
    ds_read_b128 v[136:139], v12 offset:26624
    ds_read_b128 v[140:143], v12 offset:27648
    s_waitcnt lgkmcnt(10)
    v_mfma_f32_32x32x16_bf16 v[208:223], v[104:107], v[80:83], v[208:223]
    s_waitcnt lgkmcnt(9)
    v_mfma_f32_32x32x16_bf16 v[224:239], v[108:111], v[80:83], v[224:239]
    s_waitcnt lgkmcnt(8)
    v_mfma_f32_32x32x16_bf16 v[240:255], v[112:115], v[80:83], v[240:255]
    s_waitcnt lgkmcnt(6)
    v_mfma_f32_32x32x16_bf16 v[144:159], v[116:119], v[84:87], v[144:159]
    s_waitcnt lgkmcnt(5)
    v_mfma_f32_32x32x16_bf16 v[160:175], v[120:123], v[84:87], v[160:175]
    s_waitcnt lgkmcnt(4)
    v_mfma_f32_32x32x16_bf16 v[176:191], v[124:127], v[84:87], v[176:191]
    s_waitcnt lgkmcnt(0)
    s_waitcnt vmcnt(12)
    s_barrier
    v_mfma_f32_32x32x16_bf16 v[192:207], v[128:131], v[84:87], v[192:207]
    ds_read_b128 v[80:83], v13 offset:16384
    ds_read_b128 v[88:91], v12 offset:28672
    ds_read_b128 v[92:95], v12 offset:29696
    v_mfma_f32_32x32x16_bf16 v[208:223], v[132:135], v[84:87], v[208:223]
    ds_read_b128 v[96:99], v12 offset:30720
    ds_read_b128 v[100:103], v12 offset:31744
    ds_read_b128 v[104:107], v12 offset:32768
    v_mfma_f32_32x32x16_bf16 v[224:239], v[136:139], v[84:87], v[224:239]
    ds_read_b128 v[108:111], v12 offset:33792
    ds_read_b128 v[112:115], v12 offset:34816
    v_mfma_f32_32x32x16_bf16 v[240:255], v[140:143], v[84:87], v[240:255]
    s_waitcnt lgkmcnt(6)
    v_mfma_f32_32x32x16_bf16 v[144:159], v[88:91], v[80:83], v[144:159]
    ds_read_b128 v[84:87], v13 offset:17408
    ds_read_b128 v[116:119], v12 offset:35840
    s_waitcnt lgkmcnt(7)
    v_mfma_f32_32x32x16_bf16 v[160:175], v[92:95], v[80:83], v[160:175]
    ds_read_b128 v[120:123], v12 offset:36864
    ds_read_b128 v[124:127], v12 offset:37888
    s_waitcnt lgkmcnt(8)
    v_mfma_f32_32x32x16_bf16 v[176:191], v[96:99], v[80:83], v[176:191]
    ds_read_b128 v[128:131], v12 offset:38912
    ds_read_b128 v[132:135], v12 offset:39936
    s_waitcnt lgkmcnt(9)
    v_mfma_f32_32x32x16_bf16 v[192:207], v[100:103], v[80:83], v[192:207]
    ds_read_b128 v[136:139], v12 offset:40960
    ds_read_b128 v[140:143], v12 offset:41984
    s_waitcnt lgkmcnt(10)
    v_mfma_f32_32x32x16_bf16 v[208:223], v[104:107], v[80:83], v[208:223]
    s_waitcnt lgkmcnt(9)
    v_mfma_f32_32x32x16_bf16 v[224:239], v[108:111], v[80:83], v[224:239]
    s_waitcnt lgkmcnt(8)
    v_mfma_f32_32x32x16_bf16 v[240:255], v[112:115], v[80:83], v[240:255]
    s_waitcnt lgkmcnt(6)
    v_mfma_f32_32x32x16_bf16 v[144:159], v[116:119], v[84:87], v[144:159]
    ds_read_b128 v[80:83], v13 offset:18432
    ds_read_b128 v[88:91], v12 offset:43008
    s_waitcnt lgkmcnt(7)
    v_mfma_f32_32x32x16_bf16 v[160:175], v[120:123], v[84:87], v[160:175]
    ds_read_b128 v[92:95], v12 offset:44032
    ds_read_b128 v[96:99], v12 offset:45056
    s_waitcnt lgkmcnt(8)
    v_mfma_f32_32x32x16_bf16 v[176:191], v[124:127], v[84:87], v[176:191]
    ds_read_b128 v[100:103], v12 offset:46080
    ds_read_b128 v[104:107], v12 offset:47104
    s_waitcnt lgkmcnt(9)
    v_mfma_f32_32x32x16_bf16 v[192:207], v[128:131], v[84:87], v[192:207]
    ds_read_b128 v[108:111], v12 offset:48128
    ds_read_b128 v[112:115], v12 offset:49152
    s_waitcnt lgkmcnt(10)
    v_mfma_f32_32x32x16_bf16 v[208:223], v[132:135], v[84:87], v[208:223]
    s_waitcnt lgkmcnt(9)
    v_mfma_f32_32x32x16_bf16 v[224:239], v[136:139], v[84:87], v[224:239]
    s_waitcnt lgkmcnt(8)
    v_mfma_f32_32x32x16_bf16 v[240:255], v[140:143], v[84:87], v[240:255]
    s_waitcnt lgkmcnt(6)
    v_mfma_f32_32x32x16_bf16 v[144:159], v[88:91], v[80:83], v[144:159]
    ds_read_b128 v[84:87], v13 offset:19456
    ds_read_b128 v[116:119], v12 offset:50176
    s_waitcnt lgkmcnt(7)
    v_mfma_f32_32x32x16_bf16 v[160:175], v[92:95], v[80:83], v[160:175]
    ds_read_b128 v[120:123], v12 offset:51200
    ds_read_b128 v[124:127], v12 offset:52224
    s_waitcnt lgkmcnt(8)
    v_mfma_f32_32x32x16_bf16 v[176:191], v[96:99], v[80:83], v[176:191]
    ds_read_b128 v[128:131], v12 offset:53248
    ds_read_b128 v[132:135], v12 offset:54272
    s_waitcnt lgkmcnt(9)
    v_mfma_f32_32x32x16_bf16 v[192:207], v[100:103], v[80:83], v[192:207]
    ds_read_b128 v[136:139], v12 offset:55296
    ds_read_b128 v[140:143], v12 offset:56320
    s_waitcnt lgkmcnt(10)
    v_mfma_f32_32x32x16_bf16 v[208:223], v[104:107], v[80:83], v[208:223]
    s_waitcnt lgkmcnt(9)
    v_mfma_f32_32x32x16_bf16 v[224:239], v[108:111], v[80:83], v[224:239]
    s_waitcnt lgkmcnt(8)
    v_mfma_f32_32x32x16_bf16 v[240:255], v[112:115], v[80:83], v[240:255]
    s_waitcnt lgkmcnt(6)
    v_mfma_f32_32x32x16_bf16 v[144:159], v[116:119], v[84:87], v[144:159]
    s_waitcnt lgkmcnt(5)
    v_mfma_f32_32x32x16_bf16 v[160:175], v[120:123], v[84:87], v[160:175]
    s_waitcnt lgkmcnt(4)
    v_mfma_f32_32x32x16_bf16 v[176:191], v[124:127], v[84:87], v[176:191]
    s_waitcnt lgkmcnt(0)
    s_waitcnt vmcnt(8)
    s_barrier
    v_mfma_f32_32x32x16_bf16 v[192:207], v[128:131], v[84:87], v[192:207]
    ds_read_b128 v[80:83], v13 offset:32768
    v_add_u32 v12, 57344, v12
    ds_read_b128 v[88:91], v12 offset:0
    v_mfma_f32_32x32x16_bf16 v[208:223], v[132:135], v[84:87], v[208:223]
    ds_read_b128 v[92:95], v12 offset:1024
    ds_read_b128 v[96:99], v12 offset:2048
    ds_read_b128 v[100:103], v12 offset:3072
    v_mfma_f32_32x32x16_bf16 v[224:239], v[136:139], v[84:87], v[224:239]
    ds_read_b128 v[104:107], v12 offset:4096
    ds_read_b128 v[108:111], v12 offset:5120
    ds_read_b128 v[112:115], v12 offset:6144
    v_mfma_f32_32x32x16_bf16 v[240:255], v[140:143], v[84:87], v[240:255]
    s_waitcnt lgkmcnt(6)
    v_mfma_f32_32x32x16_bf16 v[144:159], v[88:91], v[80:83], v[144:159]
    ds_read_b128 v[84:87], v13 offset:33792
    ds_read_b128 v[116:119], v12 offset:7168
    s_waitcnt lgkmcnt(7)
    v_mfma_f32_32x32x16_bf16 v[160:175], v[92:95], v[80:83], v[160:175]
    ds_read_b128 v[120:123], v12 offset:8192
    ds_read_b128 v[124:127], v12 offset:9216
    s_waitcnt lgkmcnt(8)
    v_mfma_f32_32x32x16_bf16 v[176:191], v[96:99], v[80:83], v[176:191]
    ds_read_b128 v[128:131], v12 offset:10240
    ds_read_b128 v[132:135], v12 offset:11264
    s_waitcnt lgkmcnt(9)
    v_mfma_f32_32x32x16_bf16 v[192:207], v[100:103], v[80:83], v[192:207]
    ds_read_b128 v[136:139], v12 offset:12288
    ds_read_b128 v[140:143], v12 offset:13312
    s_waitcnt lgkmcnt(10)
    v_mfma_f32_32x32x16_bf16 v[208:223], v[104:107], v[80:83], v[208:223]
    s_waitcnt lgkmcnt(9)
    v_mfma_f32_32x32x16_bf16 v[224:239], v[108:111], v[80:83], v[224:239]
    s_waitcnt lgkmcnt(8)
    v_mfma_f32_32x32x16_bf16 v[240:255], v[112:115], v[80:83], v[240:255]
    s_waitcnt lgkmcnt(6)
    v_mfma_f32_32x32x16_bf16 v[144:159], v[116:119], v[84:87], v[144:159]
    ds_read_b128 v[80:83], v13 offset:34816
    ds_read_b128 v[88:91], v12 offset:14336
    s_waitcnt lgkmcnt(7)
    v_mfma_f32_32x32x16_bf16 v[160:175], v[120:123], v[84:87], v[160:175]
    ds_read_b128 v[92:95], v12 offset:15360
    ds_read_b128 v[96:99], v12 offset:16384
    s_waitcnt lgkmcnt(8)
    v_mfma_f32_32x32x16_bf16 v[176:191], v[124:127], v[84:87], v[176:191]
    ds_read_b128 v[100:103], v12 offset:17408
    ds_read_b128 v[104:107], v12 offset:18432
    s_waitcnt lgkmcnt(9)
    v_mfma_f32_32x32x16_bf16 v[192:207], v[128:131], v[84:87], v[192:207]
    ds_read_b128 v[108:111], v12 offset:19456
    ds_read_b128 v[112:115], v12 offset:20480
    s_waitcnt lgkmcnt(10)
    v_mfma_f32_32x32x16_bf16 v[208:223], v[132:135], v[84:87], v[208:223]
    s_waitcnt lgkmcnt(9)
    v_mfma_f32_32x32x16_bf16 v[224:239], v[136:139], v[84:87], v[224:239]
    s_waitcnt lgkmcnt(8)
    v_mfma_f32_32x32x16_bf16 v[240:255], v[140:143], v[84:87], v[240:255]
    s_waitcnt lgkmcnt(6)
    v_mfma_f32_32x32x16_bf16 v[144:159], v[88:91], v[80:83], v[144:159]
    ds_read_b128 v[84:87], v13 offset:35840
    ds_read_b128 v[116:119], v12 offset:21504
    s_waitcnt vmcnt(0)
    v_add_f32 v4, v20, v22
    s_waitcnt lgkmcnt(7)
    v_mfma_f32_32x32x16_bf16 v[160:175], v[92:95], v[80:83], v[160:175]
    ds_read_b128 v[120:123], v12 offset:22528
    ds_read_b128 v[124:127], v12 offset:23552
    v_add_f32 v5, v21, v23
    v_add_f32 v4, v4, v24
    s_waitcnt lgkmcnt(8)
    v_mfma_f32_32x32x16_bf16 v[176:191], v[96:99], v[80:83], v[176:191]
    ds_read_b128 v[128:131], v12 offset:24576
    ds_read_b128 v[132:135], v12 offset:25600
    v_add_f32 v5, v5, v25
    v_add_f32 v4, v4, v26
    s_waitcnt lgkmcnt(9)
    v_mfma_f32_32x32x16_bf16 v[192:207], v[100:103], v[80:83], v[192:207]
    ds_read_b128 v[136:139], v12 offset:26624
    ds_read_b128 v[140:143], v12 offset:27648
    v_add_f32 v5, v5, v27
    v_add_f32 v4, v4, v28
    s_waitcnt lgkmcnt(10)
    v_mfma_f32_32x32x16_bf16 v[208:223], v[104:107], v[80:83], v[208:223]
    v_add_f32 v5, v5, v29
    v_add_f32 v4, v4, v30
    s_waitcnt lgkmcnt(9)
    v_mfma_f32_32x32x16_bf16 v[224:239], v[108:111], v[80:83], v[224:239]
    s_waitcnt lgkmcnt(8)
    v_mfma_f32_32x32x16_bf16 v[240:255], v[112:115], v[80:83], v[240:255]
    s_waitcnt lgkmcnt(6)
    v_mfma_f32_32x32x16_bf16 v[144:159], v[116:119], v[84:87], v[144:159]
    v_add_f32 v5, v5, v31
    v_add_f32 v4, v4, v32
    s_waitcnt lgkmcnt(5)
    v_mfma_f32_32x32x16_bf16 v[160:175], v[120:123], v[84:87], v[160:175]
    v_add_f32 v5, v5, v33
    v_add_f32 v4, v4, v34
    s_waitcnt lgkmcnt(4)
    v_mfma_f32_32x32x16_bf16 v[176:191], v[124:127], v[84:87], v[176:191]
    v_add_f32 v5, v5, v35
    v_add_f32 v4, v4, v36
    s_waitcnt lgkmcnt(0)
    s_barrier
    v_mfma_f32_32x32x16_bf16 v[192:207], v[128:131], v[84:87], v[192:207]
    ds_read_b128 v[80:83], v13 offset:0
    ds_read_b128 v[88:91], v12 offset:28672
    ds_read_b128 v[92:95], v12 offset:29696
    v_add_f32 v5, v5, v37
    v_add_f32 v4, v4, v38
    v_mfma_f32_32x32x16_bf16 v[208:223], v[132:135], v[84:87], v[208:223]
    ds_read_b128 v[96:99], v12 offset:30720
    ds_read_b128 v[100:103], v12 offset:31744
    ds_read_b128 v[104:107], v12 offset:32768
    v_add_f32 v5, v5, v39
    v_add_f32 v4, v4, v40
    v_mfma_f32_32x32x16_bf16 v[224:239], v[136:139], v[84:87], v[224:239]
    ds_read_b128 v[108:111], v12 offset:33792
    ds_read_b128 v[112:115], v12 offset:34816
    v_mfma_f32_32x32x16_bf16 v[240:255], v[140:143], v[84:87], v[240:255]
    s_waitcnt lgkmcnt(6)
    v_mfma_f32_32x32x16_bf16 v[144:159], v[88:91], v[80:83], v[144:159]
    ds_read_b128 v[84:87], v13 offset:1024
    ds_read_b128 v[116:119], v12 offset:35840
    v_add_f32 v5, v5, v41
    v_add_f32 v4, v4, v42
    s_waitcnt lgkmcnt(7)
    v_mfma_f32_32x32x16_bf16 v[160:175], v[92:95], v[80:83], v[160:175]
    ds_read_b128 v[120:123], v12 offset:36864
    ds_read_b128 v[124:127], v12 offset:37888
    v_add_f32 v5, v5, v43
    v_add_f32 v4, v4, v44
    s_waitcnt lgkmcnt(8)
    v_mfma_f32_32x32x16_bf16 v[176:191], v[96:99], v[80:83], v[176:191]
    ds_read_b128 v[128:131], v12 offset:38912
    ds_read_b128 v[132:135], v12 offset:39936
    v_add_f32 v5, v5, v45
    v_add_f32 v4, v4, v46
    s_waitcnt lgkmcnt(9)
    v_mfma_f32_32x32x16_bf16 v[192:207], v[100:103], v[80:83], v[192:207]
    ds_read_b128 v[136:139], v12 offset:40960
    ds_read_b128 v[140:143], v12 offset:41984
    v_add_f32 v5, v5, v47
    v_add_f32 v4, v4, v48
    s_waitcnt lgkmcnt(10)
    v_mfma_f32_32x32x16_bf16 v[208:223], v[104:107], v[80:83], v[208:223]
    v_add_f32 v5, v5, v49
    v_add_f32 v4, v4, v50
    s_waitcnt lgkmcnt(9)
    v_mfma_f32_32x32x16_bf16 v[224:239], v[108:111], v[80:83], v[224:239]
    s_waitcnt lgkmcnt(8)
    v_mfma_f32_32x32x16_bf16 v[240:255], v[112:115], v[80:83], v[240:255]
    s_waitcnt lgkmcnt(6)
    v_mfma_f32_32x32x16_bf16 v[144:159], v[116:119], v[84:87], v[144:159]
    ds_read_b128 v[80:83], v13 offset:2048
    ds_read_b128 v[88:91], v12 offset:43008
    v_add_f32 v5, v5, v51
    v_mov_b32 v7, v4
    s_waitcnt lgkmcnt(7)
    v_mfma_f32_32x32x16_bf16 v[160:175], v[120:123], v[84:87], v[160:175]
    ds_read_b128 v[92:95], v12 offset:44032
    ds_read_b128 v[96:99], v12 offset:45056
    s_nop 1
    v_permlane32_swap_b32 v4, v7
    s_waitcnt lgkmcnt(8)
    v_mfma_f32_32x32x16_bf16 v[176:191], v[124:127], v[84:87], v[176:191]
    ds_read_b128 v[100:103], v12 offset:46080
    ds_read_b128 v[104:107], v12 offset:47104
    s_nop 1
    v_add_f32 v4, v4, v7
    s_waitcnt lgkmcnt(9)
    v_mfma_f32_32x32x16_bf16 v[192:207], v[128:131], v[84:87], v[192:207]
    ds_read_b128 v[108:111], v12 offset:48128
    ds_read_b128 v[112:115], v12 offset:49152
    v_mov_b32 v7, v5
    s_nop 1
    s_waitcnt lgkmcnt(10)
    v_mfma_f32_32x32x16_bf16 v[208:223], v[132:135], v[84:87], v[208:223]
    v_permlane32_swap_b32 v5, v7
    s_nop 1
    s_waitcnt lgkmcnt(9)
    v_mfma_f32_32x32x16_bf16 v[224:239], v[136:139], v[84:87], v[224:239]
    s_waitcnt lgkmcnt(8)
    v_mfma_f32_32x32x16_bf16 v[240:255], v[140:143], v[84:87], v[240:255]
    s_waitcnt lgkmcnt(6)
    v_mfma_f32_32x32x16_bf16 v[144:159], v[88:91], v[80:83], v[144:159]
    ds_read_b128 v[84:87], v13 offset:3072
    ds_read_b128 v[116:119], v12 offset:50176
    v_add_f32 v5, v5, v7
    v_mul_f32 v6, 0x3b000000, v5
    s_waitcnt lgkmcnt(7)
    v_mfma_f32_32x32x16_bf16 v[160:175], v[92:95], v[80:83], v[160:175]
    ds_read_b128 v[120:123], v12 offset:51200
    ds_read_b128 v[124:127], v12 offset:52224
    v_mul_f32 v5, 0x3b000000, v4
    v_fma_f32 v6, -v5, v5, v6
    s_waitcnt lgkmcnt(8)
    v_mfma_f32_32x32x16_bf16 v[176:191], v[96:99], v[80:83], v[176:191]
    ds_read_b128 v[128:131], v12 offset:53248
    ds_read_b128 v[132:135], v12 offset:54272
    v_max_f32 v6, 0, v6
    v_add_f32 v6, 0x3727c5ac, v6
    s_waitcnt lgkmcnt(9)
    v_mfma_f32_32x32x16_bf16 v[192:207], v[100:103], v[80:83], v[192:207]
    ds_read_b128 v[136:139], v12 offset:55296
    ds_read_b128 v[140:143], v12 offset:56320
    v_rsq_f32 v7, v6
    v_sub_f32 v5, 0, v5
    s_waitcnt lgkmcnt(10)
    v_mfma_f32_32x32x16_bf16 v[208:223], v[104:107], v[80:83], v[208:223]
    v_cvt_pk_bf16_f32 v20, v5, v5
    v_and_b32 v3, s43, v20
    s_waitcnt lgkmcnt(9)
    v_mfma_f32_32x32x16_bf16 v[224:239], v[108:111], v[80:83], v[224:239]
    s_waitcnt lgkmcnt(8)
    v_mfma_f32_32x32x16_bf16 v[240:255], v[112:115], v[80:83], v[240:255]
    s_waitcnt lgkmcnt(6)
    v_mfma_f32_32x32x16_bf16 v[144:159], v[116:119], v[84:87], v[144:159]
    v_sub_f32 v3, v5, v3
    v_cvt_pk_bf16_f32 v21, v3, v3
    s_waitcnt lgkmcnt(5)
    v_mfma_f32_32x32x16_bf16 v[160:175], v[120:123], v[84:87], v[160:175]
    v_mov_b32 v22, 0
    v_mov_b32 v23, 0
    s_waitcnt lgkmcnt(4)
    v_mfma_f32_32x32x16_bf16 v[176:191], v[124:127], v[84:87], v[176:191]
    v_mul_f32 v8, 0xc0135761, v7
    v_mul_f32 v10, v7, v7
    s_waitcnt lgkmcnt(0)
    s_barrier
    v_mfma_f32_32x32x16_bf16 v[192:207], v[128:131], v[84:87], v[192:207]
    ds_read_b128 v[80:83], v13 offset:16384
    v_subrev_u32 v12, 57344, v12
    ds_read_b128 v[88:91], v12 offset:0
    v_mul_f32 v10, v10, v8
    v_mul_f32 v10, 0x3d372713, v10
    v_mfma_f32_32x32x16_bf16 v[208:223], v[132:135], v[84:87], v[208:223]
    ds_read_b128 v[92:95], v12 offset:1024
    ds_read_b128 v[96:99], v12 offset:2048
    ds_read_b128 v[100:103], v12 offset:3072
    v_mfma_f32_32x32x16_bf16 v[224:239], v[136:139], v[84:87], v[224:239]
    ds_read_b128 v[104:107], v12 offset:4096
    ds_read_b128 v[108:111], v12 offset:5120
    ds_read_b128 v[112:115], v12 offset:6144
    v_mfma_f32_32x32x16_bf16 v[240:255], v[140:143], v[84:87], v[240:255]
    s_waitcnt lgkmcnt(6)
    v_mfma_f32_32x32x16_bf16 v[144:159], v[88:91], v[80:83], v[144:159]
    ds_read_b128 v[84:87], v13 offset:17408
    ds_read_b128 v[116:119], v12 offset:7168
    s_waitcnt lgkmcnt(7)
    v_mfma_f32_32x32x16_bf16 v[160:175], v[92:95], v[80:83], v[160:175]
    ds_read_b128 v[120:123], v12 offset:8192
    ds_read_b128 v[124:127], v12 offset:9216
    s_waitcnt lgkmcnt(8)
    v_mfma_f32_32x32x16_bf16 v[176:191], v[96:99], v[80:83], v[176:191]
    ds_read_b128 v[128:131], v12 offset:10240
    ds_read_b128 v[132:135], v12 offset:11264
    s_waitcnt lgkmcnt(9)
    v_mfma_f32_32x32x16_bf16 v[192:207], v[100:103], v[80:83], v[192:207]
    ds_read_b128 v[136:139], v12 offset:12288
    ds_read_b128 v[140:143], v12 offset:13312
    s_waitcnt lgkmcnt(10)
    v_mfma_f32_32x32x16_bf16 v[208:223], v[104:107], v[80:83], v[208:223]
    s_waitcnt lgkmcnt(9)
    v_mfma_f32_32x32x16_bf16 v[224:239], v[108:111], v[80:83], v[224:239]
    s_waitcnt lgkmcnt(8)
    v_mfma_f32_32x32x16_bf16 v[240:255], v[112:115], v[80:83], v[240:255]
    s_waitcnt lgkmcnt(6)
    v_mfma_f32_32x32x16_bf16 v[144:159], v[116:119], v[84:87], v[144:159]
    ds_read_b128 v[80:83], v13 offset:18432
    ds_read_b128 v[88:91], v12 offset:14336
    s_waitcnt lgkmcnt(7)
    v_mfma_f32_32x32x16_bf16 v[160:175], v[120:123], v[84:87], v[160:175]
    ds_read_b128 v[92:95], v12 offset:15360
    ds_read_b128 v[96:99], v12 offset:16384
    s_waitcnt lgkmcnt(8)
    v_mfma_f32_32x32x16_bf16 v[176:191], v[124:127], v[84:87], v[176:191]
    ds_read_b128 v[100:103], v12 offset:17408
    ds_read_b128 v[104:107], v12 offset:18432
    s_waitcnt lgkmcnt(9)
    v_mfma_f32_32x32x16_bf16 v[192:207], v[128:131], v[84:87], v[192:207]
    ds_read_b128 v[108:111], v12 offset:19456
    ds_read_b128 v[112:115], v12 offset:20480
    s_waitcnt lgkmcnt(10)
    v_mfma_f32_32x32x16_bf16 v[208:223], v[132:135], v[84:87], v[208:223]
    s_waitcnt lgkmcnt(9)
    v_mfma_f32_32x32x16_bf16 v[224:239], v[136:139], v[84:87], v[224:239]
    s_waitcnt lgkmcnt(8)
    v_mfma_f32_32x32x16_bf16 v[240:255], v[140:143], v[84:87], v[240:255]
    v_mfma_f32_32x32x16_bf16 v[144:159], v[52:55], v[20:23], v[144:159]
    v_mfma_f32_32x32x16_bf16 v[160:175], v[56:59], v[20:23], v[160:175]
    v_mfma_f32_32x32x16_bf16 v[176:191], v[60:63], v[20:23], v[176:191]
    v_mfma_f32_32x32x16_bf16 v[192:207], v[64:67], v[20:23], v[192:207]
    v_mfma_f32_32x32x16_bf16 v[208:223], v[68:71], v[20:23], v[208:223]
    v_mfma_f32_32x32x16_bf16 v[224:239], v[72:75], v[20:23], v[224:239]
    v_mfma_f32_32x32x16_bf16 v[240:255], v[76:79], v[20:23], v[240:255]
    s_waitcnt lgkmcnt(6)
    v_mfma_f32_32x32x16_bf16 v[144:159], v[88:91], v[80:83], v[144:159]
    ds_read_b128 v[84:87], v13 offset:19456
    ds_read_b128 v[116:119], v12 offset:21504
    s_waitcnt lgkmcnt(7)
    v_mfma_f32_32x32x16_bf16 v[160:175], v[92:95], v[80:83], v[160:175]
    ds_read_b128 v[120:123], v12 offset:22528
    ds_read_b128 v[124:127], v12 offset:23552
    s_waitcnt lgkmcnt(8)
    v_mfma_f32_32x32x16_bf16 v[176:191], v[96:99], v[80:83], v[176:191]
    ds_read_b128 v[128:131], v12 offset:24576
    ds_read_b128 v[132:135], v12 offset:25600
    s_waitcnt lgkmcnt(9)
    v_mfma_f32_32x32x16_bf16 v[192:207], v[100:103], v[80:83], v[192:207]
    ds_read_b128 v[136:139], v12 offset:26624
    ds_read_b128 v[140:143], v12 offset:27648
    s_waitcnt lgkmcnt(10)
    v_mfma_f32_32x32x16_bf16 v[208:223], v[104:107], v[80:83], v[208:223]
    s_waitcnt lgkmcnt(9)
    v_mfma_f32_32x32x16_bf16 v[224:239], v[108:111], v[80:83], v[224:239]
    s_waitcnt lgkmcnt(8)
    v_mfma_f32_32x32x16_bf16 v[240:255], v[112:115], v[80:83], v[240:255]
    s_waitcnt lgkmcnt(6)
    v_mfma_f32_32x32x16_bf16 v[144:159], v[116:119], v[84:87], v[144:159]
    s_waitcnt lgkmcnt(5)
    v_mfma_f32_32x32x16_bf16 v[160:175], v[120:123], v[84:87], v[160:175]
    s_waitcnt lgkmcnt(4)
    v_mfma_f32_32x32x16_bf16 v[176:191], v[124:127], v[84:87], v[176:191]
    s_waitcnt lgkmcnt(0)
    s_barrier
    v_mfma_f32_32x32x16_bf16 v[192:207], v[128:131], v[84:87], v[192:207]
    ds_read_b128 v[80:83], v13 offset:32768
    ds_read_b128 v[88:91], v12 offset:28672
    ds_read_b128 v[92:95], v12 offset:29696
    v_mfma_f32_32x32x16_bf16 v[208:223], v[132:135], v[84:87], v[208:223]
    ds_read_b128 v[96:99], v12 offset:30720
    ds_read_b128 v[100:103], v12 offset:31744
    ds_read_b128 v[104:107], v12 offset:32768
    v_mfma_f32_32x32x16_bf16 v[224:239], v[136:139], v[84:87], v[224:239]
    ds_read_b128 v[108:111], v12 offset:33792
    ds_read_b128 v[112:115], v12 offset:34816
    v_mfma_f32_32x32x16_bf16 v[240:255], v[140:143], v[84:87], v[240:255]
    s_waitcnt lgkmcnt(6)
    v_mfma_f32_32x32x16_bf16 v[144:159], v[88:91], v[80:83], v[144:159]
    ds_read_b128 v[84:87], v13 offset:33792
    ds_read_b128 v[116:119], v12 offset:35840
    s_waitcnt lgkmcnt(7)
    v_mfma_f32_32x32x16_bf16 v[160:175], v[92:95], v[80:83], v[160:175]
    ds_read_b128 v[120:123], v12 offset:36864
    ds_read_b128 v[124:127], v12 offset:37888
    s_waitcnt lgkmcnt(8)
    v_mfma_f32_32x32x16_bf16 v[176:191], v[96:99], v[80:83], v[176:191]
    ds_read_b128 v[128:131], v12 offset:38912
    ds_read_b128 v[132:135], v12 offset:39936
    s_waitcnt lgkmcnt(9)
    v_mfma_f32_32x32x16_bf16 v[192:207], v[100:103], v[80:83], v[192:207]
    ds_read_b128 v[136:139], v12 offset:40960
    ds_read_b128 v[140:143], v12 offset:41984
    s_waitcnt lgkmcnt(10)
    v_mfma_f32_32x32x16_bf16 v[208:223], v[104:107], v[80:83], v[208:223]
    s_waitcnt lgkmcnt(9)
    v_mfma_f32_32x32x16_bf16 v[224:239], v[108:111], v[80:83], v[224:239]
    s_waitcnt lgkmcnt(8)
    v_mfma_f32_32x32x16_bf16 v[240:255], v[112:115], v[80:83], v[240:255]
    s_waitcnt lgkmcnt(6)
    v_mfma_f32_32x32x16_bf16 v[144:159], v[116:119], v[84:87], v[144:159]
    ds_read_b128 v[80:83], v13 offset:34816
    ds_read_b128 v[88:91], v12 offset:43008
    s_waitcnt lgkmcnt(7)
    v_mfma_f32_32x32x16_bf16 v[160:175], v[120:123], v[84:87], v[160:175]
    ds_read_b128 v[92:95], v12 offset:44032
    ds_read_b128 v[96:99], v12 offset:45056
    s_waitcnt lgkmcnt(8)
    v_mfma_f32_32x32x16_bf16 v[176:191], v[124:127], v[84:87], v[176:191]
    ds_read_b128 v[100:103], v12 offset:46080
    ds_read_b128 v[104:107], v12 offset:47104
    s_waitcnt lgkmcnt(9)
    v_mfma_f32_32x32x16_bf16 v[192:207], v[128:131], v[84:87], v[192:207]
    ds_read_b128 v[108:111], v12 offset:48128
    ds_read_b128 v[112:115], v12 offset:49152
    s_waitcnt lgkmcnt(10)
    v_mfma_f32_32x32x16_bf16 v[208:223], v[132:135], v[84:87], v[208:223]
    s_waitcnt lgkmcnt(9)
    v_mfma_f32_32x32x16_bf16 v[224:239], v[136:139], v[84:87], v[224:239]
    s_waitcnt lgkmcnt(8)
    v_mfma_f32_32x32x16_bf16 v[240:255], v[140:143], v[84:87], v[240:255]
    s_waitcnt lgkmcnt(6)
    v_mfma_f32_32x32x16_bf16 v[144:159], v[88:91], v[80:83], v[144:159]
    ds_read_b128 v[84:87], v13 offset:35840
    ds_read_b128 v[116:119], v12 offset:50176
    s_waitcnt lgkmcnt(7)
    v_mfma_f32_32x32x16_bf16 v[160:175], v[92:95], v[80:83], v[160:175]
    ds_read_b128 v[120:123], v12 offset:51200
    ds_read_b128 v[124:127], v12 offset:52224
    s_waitcnt lgkmcnt(8)
    v_mfma_f32_32x32x16_bf16 v[176:191], v[96:99], v[80:83], v[176:191]
    ds_read_b128 v[128:131], v12 offset:53248
    ds_read_b128 v[132:135], v12 offset:54272
    s_waitcnt lgkmcnt(9)
    v_mfma_f32_32x32x16_bf16 v[192:207], v[100:103], v[80:83], v[192:207]
    ds_read_b128 v[136:139], v12 offset:55296
    ds_read_b128 v[140:143], v12 offset:56320
    s_waitcnt lgkmcnt(10)
    v_mfma_f32_32x32x16_bf16 v[208:223], v[104:107], v[80:83], v[208:223]
    s_waitcnt lgkmcnt(9)
    v_mfma_f32_32x32x16_bf16 v[224:239], v[108:111], v[80:83], v[224:239]
    s_waitcnt lgkmcnt(8)
    v_mfma_f32_32x32x16_bf16 v[240:255], v[112:115], v[80:83], v[240:255]
    s_waitcnt lgkmcnt(6)
    v_mfma_f32_32x32x16_bf16 v[144:159], v[116:119], v[84:87], v[144:159]
    s_waitcnt lgkmcnt(5)
    v_mfma_f32_32x32x16_bf16 v[160:175], v[120:123], v[84:87], v[160:175]
    s_waitcnt lgkmcnt(4)
    v_mfma_f32_32x32x16_bf16 v[176:191], v[124:127], v[84:87], v[176:191]
    s_waitcnt lgkmcnt(0)
    s_barrier
    v_mfma_f32_32x32x16_bf16 v[192:207], v[128:131], v[84:87], v[192:207]
    ds_read_b128 v[80:83], v13 offset:0
    v_add_u32 v12, 57344, v12
    ds_read_b128 v[88:91], v12 offset:0
    v_mfma_f32_32x32x16_bf16 v[208:223], v[132:135], v[84:87], v[208:223]
    ds_read_b128 v[92:95], v12 offset:1024
    ds_read_b128 v[96:99], v12 offset:2048
    ds_read_b128 v[100:103], v12 offset:3072
    v_mfma_f32_32x32x16_bf16 v[224:239], v[136:139], v[84:87], v[224:239]
    ds_read_b128 v[104:107], v12 offset:4096
    ds_read_b128 v[108:111], v12 offset:5120
    ds_read_b128 v[112:115], v12 offset:6144
    v_mfma_f32_32x32x16_bf16 v[240:255], v[140:143], v[84:87], v[240:255]
    s_waitcnt lgkmcnt(6)
    v_mfma_f32_32x32x16_bf16 v[144:159], v[88:91], v[80:83], v[144:159]
    ds_read_b128 v[84:87], v13 offset:1024
    ds_read_b128 v[116:119], v12 offset:7168
    s_waitcnt lgkmcnt(7)
    v_mfma_f32_32x32x16_bf16 v[160:175], v[92:95], v[80:83], v[160:175]
    ds_read_b128 v[120:123], v12 offset:8192
    ds_read_b128 v[124:127], v12 offset:9216
    s_waitcnt lgkmcnt(8)
    v_mfma_f32_32x32x16_bf16 v[176:191], v[96:99], v[80:83], v[176:191]
    ds_read_b128 v[128:131], v12 offset:10240
    ds_read_b128 v[132:135], v12 offset:11264
    s_waitcnt lgkmcnt(9)
    v_mfma_f32_32x32x16_bf16 v[192:207], v[100:103], v[80:83], v[192:207]
    ds_read_b128 v[136:139], v12 offset:12288
    ds_read_b128 v[140:143], v12 offset:13312
    s_waitcnt lgkmcnt(10)
    v_mfma_f32_32x32x16_bf16 v[208:223], v[104:107], v[80:83], v[208:223]
    s_waitcnt lgkmcnt(9)
    v_mfma_f32_32x32x16_bf16 v[224:239], v[108:111], v[80:83], v[224:239]
    s_waitcnt lgkmcnt(8)
    v_mfma_f32_32x32x16_bf16 v[240:255], v[112:115], v[80:83], v[240:255]
    s_waitcnt lgkmcnt(6)
    v_mfma_f32_32x32x16_bf16 v[144:159], v[116:119], v[84:87], v[144:159]
    ds_read_b128 v[80:83], v13 offset:2048
    ds_read_b128 v[88:91], v12 offset:14336
    s_waitcnt lgkmcnt(7)
    v_mfma_f32_32x32x16_bf16 v[160:175], v[120:123], v[84:87], v[160:175]
    ds_read_b128 v[92:95], v12 offset:15360
    ds_read_b128 v[96:99], v12 offset:16384
    s_waitcnt lgkmcnt(8)
    v_mfma_f32_32x32x16_bf16 v[176:191], v[124:127], v[84:87], v[176:191]
    ds_read_b128 v[100:103], v12 offset:17408
    ds_read_b128 v[104:107], v12 offset:18432
    s_waitcnt lgkmcnt(9)
    v_mfma_f32_32x32x16_bf16 v[192:207], v[128:131], v[84:87], v[192:207]
    ds_read_b128 v[108:111], v12 offset:19456
    ds_read_b128 v[112:115], v12 offset:20480
    s_waitcnt lgkmcnt(10)
    v_mfma_f32_32x32x16_bf16 v[208:223], v[132:135], v[84:87], v[208:223]
    s_waitcnt lgkmcnt(9)
    v_mfma_f32_32x32x16_bf16 v[224:239], v[136:139], v[84:87], v[224:239]
    s_waitcnt lgkmcnt(8)
    v_mfma_f32_32x32x16_bf16 v[240:255], v[140:143], v[84:87], v[240:255]
    s_waitcnt lgkmcnt(6)
    v_mfma_f32_32x32x16_bf16 v[144:159], v[88:91], v[80:83], v[144:159]
    ds_read_b128 v[84:87], v13 offset:3072
    ds_read_b128 v[116:119], v12 offset:21504
    s_waitcnt lgkmcnt(7)
    v_mfma_f32_32x32x16_bf16 v[160:175], v[92:95], v[80:83], v[160:175]
    ds_read_b128 v[120:123], v12 offset:22528
    ds_read_b128 v[124:127], v12 offset:23552
    s_waitcnt lgkmcnt(8)
    v_mfma_f32_32x32x16_bf16 v[176:191], v[96:99], v[80:83], v[176:191]
    ds_read_b128 v[128:131], v12 offset:24576
    ds_read_b128 v[132:135], v12 offset:25600
    s_waitcnt lgkmcnt(9)
    v_mfma_f32_32x32x16_bf16 v[192:207], v[100:103], v[80:83], v[192:207]
    ds_read_b128 v[136:139], v12 offset:26624
    ds_read_b128 v[140:143], v12 offset:27648
    s_waitcnt lgkmcnt(10)
    v_mfma_f32_32x32x16_bf16 v[208:223], v[104:107], v[80:83], v[208:223]
    s_waitcnt lgkmcnt(9)
    v_mfma_f32_32x32x16_bf16 v[224:239], v[108:111], v[80:83], v[224:239]
    s_waitcnt lgkmcnt(8)
    v_mfma_f32_32x32x16_bf16 v[240:255], v[112:115], v[80:83], v[240:255]
    s_waitcnt lgkmcnt(6)
    v_mfma_f32_32x32x16_bf16 v[144:159], v[116:119], v[84:87], v[144:159]
    s_waitcnt lgkmcnt(5)
    v_mfma_f32_32x32x16_bf16 v[160:175], v[120:123], v[84:87], v[160:175]
    s_waitcnt lgkmcnt(4)
    v_mfma_f32_32x32x16_bf16 v[176:191], v[124:127], v[84:87], v[176:191]
    s_waitcnt lgkmcnt(0)
    s_barrier
    v_mfma_f32_32x32x16_bf16 v[192:207], v[128:131], v[84:87], v[192:207]
    ds_read_b128 v[80:83], v13 offset:16384
    ds_read_b128 v[88:91], v12 offset:28672
    ds_read_b128 v[92:95], v12 offset:29696
    v_mfma_f32_32x32x16_bf16 v[208:223], v[132:135], v[84:87], v[208:223]
    ds_read_b128 v[96:99], v12 offset:30720
    ds_read_b128 v[100:103], v12 offset:31744
    ds_read_b128 v[104:107], v12 offset:32768
    v_mfma_f32_32x32x16_bf16 v[224:239], v[136:139], v[84:87], v[224:239]
    ds_read_b128 v[108:111], v12 offset:33792
    ds_read_b128 v[112:115], v12 offset:34816
    v_mfma_f32_32x32x16_bf16 v[240:255], v[140:143], v[84:87], v[240:255]
    s_waitcnt lgkmcnt(6)
    v_mfma_f32_32x32x16_bf16 v[144:159], v[88:91], v[80:83], v[144:159]
    ds_read_b128 v[84:87], v13 offset:17408
    ds_read_b128 v[116:119], v12 offset:35840
    s_waitcnt lgkmcnt(7)
    v_mfma_f32_32x32x16_bf16 v[160:175], v[92:95], v[80:83], v[160:175]
    ds_read_b128 v[120:123], v12 offset:36864
    ds_read_b128 v[124:127], v12 offset:37888
    s_waitcnt lgkmcnt(8)
    v_mfma_f32_32x32x16_bf16 v[176:191], v[96:99], v[80:83], v[176:191]
    ds_read_b128 v[128:131], v12 offset:38912
    ds_read_b128 v[132:135], v12 offset:39936
    s_waitcnt lgkmcnt(9)
    v_mfma_f32_32x32x16_bf16 v[192:207], v[100:103], v[80:83], v[192:207]
    ds_read_b128 v[136:139], v12 offset:40960
    ds_read_b128 v[140:143], v12 offset:41984
    s_waitcnt lgkmcnt(10)
    v_mfma_f32_32x32x16_bf16 v[208:223], v[104:107], v[80:83], v[208:223]
    s_waitcnt lgkmcnt(9)
    v_mfma_f32_32x32x16_bf16 v[224:239], v[108:111], v[80:83], v[224:239]
    s_waitcnt lgkmcnt(8)
    v_mfma_f32_32x32x16_bf16 v[240:255], v[112:115], v[80:83], v[240:255]
    s_waitcnt lgkmcnt(6)
    v_mfma_f32_32x32x16_bf16 v[144:159], v[116:119], v[84:87], v[144:159]
    ds_read_b128 v[80:83], v13 offset:18432
    ds_read_b128 v[88:91], v12 offset:43008
    s_waitcnt lgkmcnt(7)
    v_mfma_f32_32x32x16_bf16 v[160:175], v[120:123], v[84:87], v[160:175]
    ds_read_b128 v[92:95], v12 offset:44032
    ds_read_b128 v[96:99], v12 offset:45056
    s_waitcnt lgkmcnt(8)
    v_mfma_f32_32x32x16_bf16 v[176:191], v[124:127], v[84:87], v[176:191]
    ds_read_b128 v[100:103], v12 offset:46080
    ds_read_b128 v[104:107], v12 offset:47104
    s_waitcnt lgkmcnt(9)
    v_mfma_f32_32x32x16_bf16 v[192:207], v[128:131], v[84:87], v[192:207]
    ds_read_b128 v[108:111], v12 offset:48128
    ds_read_b128 v[112:115], v12 offset:49152
    s_waitcnt lgkmcnt(10)
    v_mfma_f32_32x32x16_bf16 v[208:223], v[132:135], v[84:87], v[208:223]
    s_waitcnt lgkmcnt(9)
    v_mfma_f32_32x32x16_bf16 v[224:239], v[136:139], v[84:87], v[224:239]
    s_waitcnt lgkmcnt(8)
    v_mfma_f32_32x32x16_bf16 v[240:255], v[140:143], v[84:87], v[240:255]
    s_waitcnt lgkmcnt(6)
    v_mfma_f32_32x32x16_bf16 v[144:159], v[88:91], v[80:83], v[144:159]
    ds_read_b128 v[84:87], v13 offset:19456
    ds_read_b128 v[116:119], v12 offset:50176
    s_mul_i32 s32, s49, 112
    s_mul_i32 s33, s28, 7
    s_waitcnt lgkmcnt(7)
    v_mfma_f32_32x32x16_bf16 v[160:175], v[92:95], v[80:83], v[160:175]
    ds_read_b128 v[120:123], v12 offset:51200
    ds_read_b128 v[124:127], v12 offset:52224
    s_add_u32 s32, s32, s33
    s_lshl_b32 s32, s32, 10
    s_waitcnt lgkmcnt(8)
    v_mfma_f32_32x32x16_bf16 v[176:191], v[96:99], v[80:83], v[176:191]
    ds_read_b128 v[128:131], v12 offset:53248
    ds_read_b128 v[132:135], v12 offset:54272
    s_add_u32 s32, s32, 10485760
    s_add_u32 s33, s32, 4096
    s_waitcnt lgkmcnt(9)
    v_mfma_f32_32x32x16_bf16 v[192:207], v[100:103], v[80:83], v[192:207]
    ds_read_b128 v[136:139], v12 offset:55296
    ds_read_b128 v[140:143], v12 offset:56320
    s_waitcnt lgkmcnt(10)
    v_mfma_f32_32x32x16_bf16 v[208:223], v[104:107], v[80:83], v[208:223]
    s_waitcnt lgkmcnt(9)
    v_mfma_f32_32x32x16_bf16 v[224:239], v[108:111], v[80:83], v[224:239]
    s_waitcnt lgkmcnt(8)
    v_mfma_f32_32x32x16_bf16 v[240:255], v[112:115], v[80:83], v[240:255]
    s_waitcnt lgkmcnt(6)
    v_mfma_f32_32x32x16_bf16 v[144:159], v[116:119], v[84:87], v[144:159]
    s_waitcnt lgkmcnt(5)
    v_mfma_f32_32x32x16_bf16 v[160:175], v[120:123], v[84:87], v[160:175]
    s_waitcnt lgkmcnt(4)
    v_mfma_f32_32x32x16_bf16 v[176:191], v[124:127], v[84:87], v[176:191]
    s_waitcnt lgkmcnt(3)
    v_mfma_f32_32x32x16_bf16 v[192:207], v[128:131], v[84:87], v[192:207]
    s_waitcnt lgkmcnt(2)
    v_mfma_f32_32x32x16_bf16 v[208:223], v[132:135], v[84:87], v[208:223]
    s_waitcnt lgkmcnt(1)
    v_mfma_f32_32x32x16_bf16 v[224:239], v[136:139], v[84:87], v[224:239]
    s_waitcnt lgkmcnt(0)
    v_mfma_f32_32x32x16_bf16 v[240:255], v[140:143], v[84:87], v[240:255]
    s_barrier
    s_nop 4
    v_pk_mul_f32 v[88:89], v[144:145], v[144:145]
    v_pk_mul_f32 v[90:91], v[146:147], v[146:147]
    v_pk_mul_f32 v[92:93], v[148:149], v[148:149]
    v_pk_mul_f32 v[94:95], v[150:151], v[150:151]
    v_pk_fma_f32 v[88:89], v[88:89], v[10:11], v[8:9] op_sel_hi:[1,0,0]
    v_pk_fma_f32 v[90:91], v[90:91], v[10:11], v[8:9] op_sel_hi:[1,0,0]
    v_pk_fma_f32 v[92:93], v[92:93], v[10:11], v[8:9] op_sel_hi:[1,0,0]
    v_pk_fma_f32 v[94:95], v[94:95], v[10:11], v[8:9] op_sel_hi:[1,0,0]
    v_pk_mul_f32 v[88:89], v[88:89], v[144:145]
    v_pk_mul_f32 v[90:91], v[90:91], v[146:147]
    v_pk_mul_f32 v[92:93], v[92:93], v[148:149]
    v_pk_mul_f32 v[94:95], v[94:95], v[150:151]
    v_exp_f32 v88, v88
    v_exp_f32 v89, v89
    v_exp_f32 v90, v90
    v_exp_f32 v91, v91
    v_exp_f32 v92, v92
    v_exp_f32 v93, v93
    v_exp_f32 v94, v94
    v_exp_f32 v95, v95
    v_pk_mul_f32 v[144:145], v[144:145], v[152:153]
    v_pk_mul_f32 v[146:147], v[146:147], v[154:155]
    v_pk_mul_f32 v[148:149], v[148:149], v[156:157]
    v_pk_mul_f32 v[150:151], v[150:151], v[158:159]
    v_pk_fma_f32 v[88:89], v[88:89], v[6:7], v[6:7] op_sel_hi:[1,0,0]
    v_pk_fma_f32 v[90:91], v[90:91], v[6:7], v[6:7] op_sel_hi:[1,0,0]
    v_pk_fma_f32 v[92:93], v[92:93], v[6:7], v[6:7] op_sel_hi:[1,0,0]
    v_pk_fma_f32 v[94:95], v[94:95], v[6:7], v[6:7] op_sel_hi:[1,0,0]
    v_rcp_f32 v88, v88
    v_rcp_f32 v89, v89
    v_rcp_f32 v90, v90
    v_rcp_f32 v91, v91
    v_rcp_f32 v92, v92
    v_rcp_f32 v93, v93
    v_rcp_f32 v94, v94
    v_rcp_f32 v95, v95
    s_nop 0
    v_pk_mul_f32 v[144:145], v[144:145], v[88:89]
    v_pk_mul_f32 v[146:147], v[146:147], v[90:91]
    v_pk_mul_f32 v[148:149], v[148:149], v[92:93]
    v_pk_mul_f32 v[150:151], v[150:151], v[94:95]
    v_cvt_pk_bf16_f32 v104, v144, v145
    v_cvt_pk_bf16_f32 v105, v146, v147
    v_cvt_pk_bf16_f32 v106, v148, v149
    v_cvt_pk_bf16_f32 v107, v150, v151
    v_pk_mul_f32 v[96:97], v[160:161], v[160:161]
    v_pk_mul_f32 v[98:99], v[162:163], v[162:163]
    v_pk_mul_f32 v[100:101], v[164:165], v[164:165]
    v_pk_mul_f32 v[102:103], v[166:167], v[166:167]
    v_pk_fma_f32 v[96:97], v[96:97], v[10:11], v[8:9] op_sel_hi:[1,0,0]
    v_pk_fma_f32 v[98:99], v[98:99], v[10:11], v[8:9] op_sel_hi:[1,0,0]
    v_pk_fma_f32 v[100:101], v[100:101], v[10:11], v[8:9] op_sel_hi:[1,0,0]
    v_pk_fma_f32 v[102:103], v[102:103], v[10:11], v[8:9] op_sel_hi:[1,0,0]
    v_pk_mul_f32 v[96:97], v[96:97], v[160:161]
    v_pk_mul_f32 v[98:99], v[98:99], v[162:163]
    v_pk_mul_f32 v[100:101], v[100:101], v[164:165]
    v_pk_mul_f32 v[102:103], v[102:103], v[166:167]
    v_exp_f32 v96, v96
    v_exp_f32 v97, v97
    v_exp_f32 v98, v98
    v_exp_f32 v99, v99
    v_exp_f32 v100, v100
    v_exp_f32 v101, v101
    v_exp_f32 v102, v102
    v_exp_f32 v103, v103
    v_pk_mul_f32 v[160:161], v[160:161], v[168:169]
    v_pk_mul_f32 v[162:163], v[162:163], v[170:171]
    v_pk_mul_f32 v[164:165], v[164:165], v[172:173]
    v_pk_mul_f32 v[166:167], v[166:167], v[174:175]
    v_pk_fma_f32 v[96:97], v[96:97], v[6:7], v[6:7] op_sel_hi:[1,0,0]
    v_pk_fma_f32 v[98:99], v[98:99], v[6:7], v[6:7] op_sel_hi:[1,0,0]
    v_pk_fma_f32 v[100:101], v[100:101], v[6:7], v[6:7] op_sel_hi:[1,0,0]
    v_pk_fma_f32 v[102:103], v[102:103], v[6:7], v[6:7] op_sel_hi:[1,0,0]
    v_rcp_f32 v96, v96
    v_rcp_f32 v97, v97
    v_rcp_f32 v98, v98
    v_rcp_f32 v99, v99
    v_rcp_f32 v100, v100
    v_rcp_f32 v101, v101
    v_rcp_f32 v102, v102
    v_rcp_f32 v103, v103
    s_nop 0
    v_pk_mul_f32 v[160:161], v[160:161], v[96:97]
    v_pk_mul_f32 v[162:163], v[162:163], v[98:99]
    v_pk_mul_f32 v[164:165], v[164:165], v[100:101]
    v_pk_mul_f32 v[166:167], v[166:167], v[102:103]
    v_cvt_pk_bf16_f32 v108, v160, v161
    v_cvt_pk_bf16_f32 v109, v162, v163
    v_cvt_pk_bf16_f32 v110, v164, v165
    v_cvt_pk_bf16_f32 v111, v166, v167
    v_pk_mul_f32 v[88:89], v[176:177], v[176:177]
    v_pk_mul_f32 v[90:91], v[178:179], v[178:179]
    v_pk_mul_f32 v[92:93], v[180:181], v[180:181]
    v_pk_mul_f32 v[94:95], v[182:183], v[182:183]
    v_pk_fma_f32 v[88:89], v[88:89], v[10:11], v[8:9] op_sel_hi:[1,0,0]
    v_pk_fma_f32 v[90:91], v[90:91], v[10:11], v[8:9] op_sel_hi:[1,0,0]
    v_pk_fma_f32 v[92:93], v[92:93], v[10:11], v[8:9] op_sel_hi:[1,0,0]
    v_pk_fma_f32 v[94:95], v[94:95], v[10:11], v[8:9] op_sel_hi:[1,0,0]
    v_pk_mul_f32 v[88:89], v[88:89], v[176:177]
    v_pk_mul_f32 v[90:91], v[90:91], v[178:179]
    v_pk_mul_f32 v[92:93], v[92:93], v[180:181]
    v_pk_mul_f32 v[94:95], v[94:95], v[182:183]
    v_exp_f32 v88, v88
    v_exp_f32 v89, v89
    v_exp_f32 v90, v90
    v_exp_f32 v91, v91
    v_exp_f32 v92, v92
    v_exp_f32 v93, v93
    v_exp_f32 v94, v94
    v_exp_f32 v95, v95
    v_pk_mul_f32 v[176:177], v[176:177], v[184:185]
    v_pk_mul_f32 v[178:179], v[178:179], v[186:187]
    v_pk_mul_f32 v[180:181], v[180:181], v[188:189]
    v_pk_mul_f32 v[182:183], v[182:183], v[190:191]
    v_pk_fma_f32 v[88:89], v[88:89], v[6:7], v[6:7] op_sel_hi:[1,0,0]
    v_pk_fma_f32 v[90:91], v[90:91], v[6:7], v[6:7] op_sel_hi:[1,0,0]
    v_pk_fma_f32 v[92:93], v[92:93], v[6:7], v[6:7] op_sel_hi:[1,0,0]
    v_pk_fma_f32 v[94:95], v[94:95], v[6:7], v[6:7] op_sel_hi:[1,0,0]
    v_rcp_f32 v88, v88
    v_rcp_f32 v89, v89
    v_rcp_f32 v90, v90
    v_rcp_f32 v91, v91
    v_rcp_f32 v92, v92
    v_rcp_f32 v93, v93
    v_rcp_f32 v94, v94
    v_rcp_f32 v95, v95
    s_nop 0
    v_pk_mul_f32 v[176:177], v[176:177], v[88:89]
    v_pk_mul_f32 v[178:179], v[178:179], v[90:91]
    v_pk_mul_f32 v[180:181], v[180:181], v[92:93]
    v_pk_mul_f32 v[182:183], v[182:183], v[94:95]
    v_cvt_pk_bf16_f32 v112, v176, v177
    v_cvt_pk_bf16_f32 v113, v178, v179
    v_cvt_pk_bf16_f32 v114, v180, v181
    v_cvt_pk_bf16_f32 v115, v182, v183
    v_pk_mul_f32 v[96:97], v[192:193], v[192:193]
    v_pk_mul_f32 v[98:99], v[194:195], v[194:195]
    v_pk_mul_f32 v[100:101], v[196:197], v[196:197]
    v_pk_mul_f32 v[102:103], v[198:199], v[198:199]
    v_pk_fma_f32 v[96:97], v[96:97], v[10:11], v[8:9] op_sel_hi:[1,0,0]
    v_pk_fma_f32 v[98:99], v[98:99], v[10:11], v[8:9] op_sel_hi:[1,0,0]
    v_pk_fma_f32 v[100:101], v[100:101], v[10:11], v[8:9] op_sel_hi:[1,0,0]
    v_pk_fma_f32 v[102:103], v[102:103], v[10:11], v[8:9] op_sel_hi:[1,0,0]
    v_pk_mul_f32 v[96:97], v[96:97], v[192:193]
    v_pk_mul_f32 v[98:99], v[98:99], v[194:195]
    v_pk_mul_f32 v[100:101], v[100:101], v[196:197]
    v_pk_mul_f32 v[102:103], v[102:103], v[198:199]
    v_exp_f32 v96, v96
    v_exp_f32 v97, v97
    v_exp_f32 v98, v98
    v_exp_f32 v99, v99
    v_exp_f32 v100, v100
    v_exp_f32 v101, v101
    v_exp_f32 v102, v102
    v_exp_f32 v103, v103
    v_pk_mul_f32 v[192:193], v[192:193], v[200:201]
    v_pk_mul_f32 v[194:195], v[194:195], v[202:203]
    v_pk_mul_f32 v[196:197], v[196:197], v[204:205]
    v_pk_mul_f32 v[198:199], v[198:199], v[206:207]
    v_pk_fma_f32 v[96:97], v[96:97], v[6:7], v[6:7] op_sel_hi:[1,0,0]
    v_pk_fma_f32 v[98:99], v[98:99], v[6:7], v[6:7] op_sel_hi:[1,0,0]
    v_pk_fma_f32 v[100:101], v[100:101], v[6:7], v[6:7] op_sel_hi:[1,0,0]
    v_pk_fma_f32 v[102:103], v[102:103], v[6:7], v[6:7] op_sel_hi:[1,0,0]
    v_rcp_f32 v96, v96
    v_rcp_f32 v97, v97
    v_rcp_f32 v98, v98
    v_rcp_f32 v99, v99
    v_rcp_f32 v100, v100
    v_rcp_f32 v101, v101
    v_rcp_f32 v102, v102
    v_rcp_f32 v103, v103
    s_nop 0
    v_pk_mul_f32 v[192:193], v[192:193], v[96:97]
    v_pk_mul_f32 v[194:195], v[194:195], v[98:99]
    v_pk_mul_f32 v[196:197], v[196:197], v[100:101]
    v_pk_mul_f32 v[198:199], v[198:199], v[102:103]
    v_cvt_pk_bf16_f32 v116, v192, v193
    v_cvt_pk_bf16_f32 v117, v194, v195
    v_cvt_pk_bf16_f32 v118, v196, v197
    v_cvt_pk_bf16_f32 v119, v198, v199
    v_pk_mul_f32 v[88:89], v[208:209], v[208:209]
    v_pk_mul_f32 v[90:91], v[210:211], v[210:211]
    v_pk_mul_f32 v[92:93], v[212:213], v[212:213]
    v_pk_mul_f32 v[94:95], v[214:215], v[214:215]
    v_pk_fma_f32 v[88:89], v[88:89], v[10:11], v[8:9] op_sel_hi:[1,0,0]
    v_pk_fma_f32 v[90:91], v[90:91], v[10:11], v[8:9] op_sel_hi:[1,0,0]
    v_pk_fma_f32 v[92:93], v[92:93], v[10:11], v[8:9] op_sel_hi:[1,0,0]
    v_pk_fma_f32 v[94:95], v[94:95], v[10:11], v[8:9] op_sel_hi:[1,0,0]
    v_pk_mul_f32 v[88:89], v[88:89], v[208:209]
    v_pk_mul_f32 v[90:91], v[90:91], v[210:211]
    v_pk_mul_f32 v[92:93], v[92:93], v[212:213]
    v_pk_mul_f32 v[94:95], v[94:95], v[214:215]
    v_exp_f32 v88, v88
    v_exp_f32 v89, v89
    v_exp_f32 v90, v90
    v_exp_f32 v91, v91
    v_exp_f32 v92, v92
    v_exp_f32 v93, v93
    v_exp_f32 v94, v94
    v_exp_f32 v95, v95
    v_pk_mul_f32 v[208:209], v[208:209], v[216:217]
    v_pk_mul_f32 v[210:211], v[210:211], v[218:219]
    v_pk_mul_f32 v[212:213], v[212:213], v[220:221]
    v_pk_mul_f32 v[214:215], v[214:215], v[222:223]
    v_pk_fma_f32 v[88:89], v[88:89], v[6:7], v[6:7] op_sel_hi:[1,0,0]
    v_pk_fma_f32 v[90:91], v[90:91], v[6:7], v[6:7] op_sel_hi:[1,0,0]
    v_pk_fma_f32 v[92:93], v[92:93], v[6:7], v[6:7] op_sel_hi:[1,0,0]
    v_pk_fma_f32 v[94:95], v[94:95], v[6:7], v[6:7] op_sel_hi:[1,0,0]
    v_rcp_f32 v88, v88
    v_rcp_f32 v89, v89
    v_rcp_f32 v90, v90
    v_rcp_f32 v91, v91
    v_rcp_f32 v92, v92
    v_rcp_f32 v93, v93
    v_rcp_f32 v94, v94
    v_rcp_f32 v95, v95
    s_nop 0
    v_pk_mul_f32 v[208:209], v[208:209], v[88:89]
    v_pk_mul_f32 v[210:211], v[210:211], v[90:91]
    v_pk_mul_f32 v[212:213], v[212:213], v[92:93]
    v_pk_mul_f32 v[214:215], v[214:215], v[94:95]
    v_cvt_pk_bf16_f32 v120, v208, v209
    v_cvt_pk_bf16_f32 v121, v210, v211
    v_cvt_pk_bf16_f32 v122, v212, v213
    v_cvt_pk_bf16_f32 v123, v214, v215
    v_pk_mul_f32 v[96:97], v[224:225], v[224:225]
    v_pk_mul_f32 v[98:99], v[226:227], v[226:227]
    v_pk_mul_f32 v[100:101], v[228:229], v[228:229]
    v_pk_mul_f32 v[102:103], v[230:231], v[230:231]
    v_pk_fma_f32 v[96:97], v[96:97], v[10:11], v[8:9] op_sel_hi:[1,0,0]
    v_pk_fma_f32 v[98:99], v[98:99], v[10:11], v[8:9] op_sel_hi:[1,0,0]
    v_pk_fma_f32 v[100:101], v[100:101], v[10:11], v[8:9] op_sel_hi:[1,0,0]
    v_pk_fma_f32 v[102:103], v[102:103], v[10:11], v[8:9] op_sel_hi:[1,0,0]
    v_pk_mul_f32 v[96:97], v[96:97], v[224:225]
    v_pk_mul_f32 v[98:99], v[98:99], v[226:227]
    v_pk_mul_f32 v[100:101], v[100:101], v[228:229]
    v_pk_mul_f32 v[102:103], v[102:103], v[230:231]
    v_exp_f32 v96, v96
    v_exp_f32 v97, v97
    v_exp_f32 v98, v98
    v_exp_f32 v99, v99
    v_exp_f32 v100, v100
    v_exp_f32 v101, v101
    v_exp_f32 v102, v102
    v_exp_f32 v103, v103
    v_pk_mul_f32 v[224:225], v[224:225], v[232:233]
    v_pk_mul_f32 v[226:227], v[226:227], v[234:235]
    v_pk_mul_f32 v[228:229], v[228:229], v[236:237]
    v_pk_mul_f32 v[230:231], v[230:231], v[238:239]
    v_pk_fma_f32 v[96:97], v[96:97], v[6:7], v[6:7] op_sel_hi:[1,0,0]
    v_pk_fma_f32 v[98:99], v[98:99], v[6:7], v[6:7] op_sel_hi:[1,0,0]
    v_pk_fma_f32 v[100:101], v[100:101], v[6:7], v[6:7] op_sel_hi:[1,0,0]
    v_pk_fma_f32 v[102:103], v[102:103], v[6:7], v[6:7] op_sel_hi:[1,0,0]
    v_rcp_f32 v96, v96
    v_rcp_f32 v97, v97
    v_rcp_f32 v98, v98
    v_rcp_f32 v99, v99
    v_rcp_f32 v100, v100
    v_rcp_f32 v101, v101
    v_rcp_f32 v102, v102
    v_rcp_f32 v103, v103
    s_nop 0
    v_pk_mul_f32 v[224:225], v[224:225], v[96:97]
    v_pk_mul_f32 v[226:227], v[226:227], v[98:99]
    v_pk_mul_f32 v[228:229], v[228:229], v[100:101]
    v_pk_mul_f32 v[230:231], v[230:231], v[102:103]
    v_cvt_pk_bf16_f32 v124, v224, v225
    v_cvt_pk_bf16_f32 v125, v226, v227
    v_cvt_pk_bf16_f32 v126, v228, v229
    v_cvt_pk_bf16_f32 v127, v230, v231
    v_pk_mul_f32 v[88:89], v[240:241], v[240:241]
    v_pk_mul_f32 v[90:91], v[242:243], v[242:243]
    v_pk_mul_f32 v[92:93], v[244:245], v[244:245]
    v_pk_mul_f32 v[94:95], v[246:247], v[246:247]
    v_pk_fma_f32 v[88:89], v[88:89], v[10:11], v[8:9] op_sel_hi:[1,0,0]
    v_pk_fma_f32 v[90:91], v[90:91], v[10:11], v[8:9] op_sel_hi:[1,0,0]
    v_pk_fma_f32 v[92:93], v[92:93], v[10:11], v[8:9] op_sel_hi:[1,0,0]
    v_pk_fma_f32 v[94:95], v[94:95], v[10:11], v[8:9] op_sel_hi:[1,0,0]
    v_pk_mul_f32 v[88:89], v[88:89], v[240:241]
    v_pk_mul_f32 v[90:91], v[90:91], v[242:243]
    v_pk_mul_f32 v[92:93], v[92:93], v[244:245]
    v_pk_mul_f32 v[94:95], v[94:95], v[246:247]
    v_exp_f32 v88, v88
    v_exp_f32 v89, v89
    v_exp_f32 v90, v90
    v_exp_f32 v91, v91
    v_exp_f32 v92, v92
    v_exp_f32 v93, v93
    v_exp_f32 v94, v94
    v_exp_f32 v95, v95
    v_pk_mul_f32 v[240:241], v[240:241], v[248:249]
    v_pk_mul_f32 v[242:243], v[242:243], v[250:251]
    v_pk_mul_f32 v[244:245], v[244:245], v[252:253]
    v_pk_mul_f32 v[246:247], v[246:247], v[254:255]
    v_pk_fma_f32 v[88:89], v[88:89], v[6:7], v[6:7] op_sel_hi:[1,0,0]
    v_pk_fma_f32 v[90:91], v[90:91], v[6:7], v[6:7] op_sel_hi:[1,0,0]
    v_pk_fma_f32 v[92:93], v[92:93], v[6:7], v[6:7] op_sel_hi:[1,0,0]
    v_pk_fma_f32 v[94:95], v[94:95], v[6:7], v[6:7] op_sel_hi:[1,0,0]
    v_rcp_f32 v88, v88
    v_rcp_f32 v89, v89
    v_rcp_f32 v90, v90
    v_rcp_f32 v91, v91
    v_rcp_f32 v92, v92
    v_rcp_f32 v93, v93
    v_rcp_f32 v94, v94
    v_rcp_f32 v95, v95
    s_nop 0
    v_pk_mul_f32 v[240:241], v[240:241], v[88:89]
    v_pk_mul_f32 v[242:243], v[242:243], v[90:91]
    v_pk_mul_f32 v[244:245], v[244:245], v[92:93]
    v_pk_mul_f32 v[246:247], v[246:247], v[94:95]
    v_cvt_pk_bf16_f32 v128, v240, v241
    v_cvt_pk_bf16_f32 v129, v242, v243
    v_cvt_pk_bf16_f32 v130, v244, v245
    v_cvt_pk_bf16_f32 v131, v246, v247
    s_cmp_eq_u32 s63, -1
    s_cbranch_scc1 L_hs_act_f
    buffer_store_dwordx4 v[104:107], v2, s[20:23], s32 offen offset:0 sc1
    buffer_store_dwordx4 v[108:111], v2, s[20:23], s32 offen offset:1024 sc1
    buffer_store_dwordx4 v[112:115], v2, s[20:23], s32 offen offset:2048 sc1
    buffer_store_dwordx4 v[116:119], v2, s[20:23], s32 offen offset:3072 sc1
    buffer_store_dwordx4 v[120:123], v2, s[20:23], s33 offen offset:0 sc1
    buffer_store_dwordx4 v[124:127], v2, s[20:23], s33 offen offset:1024 sc1
    buffer_store_dwordx4 v[128:131], v2, s[20:23], s33 offen offset:2048 sc1
    s_branch L_hs_act_d
L_hs_act_f:
    buffer_store_dwordx4 v[104:107], v2, s[20:23], s32 offen offset:0
    buffer_store_dwordx4 v[108:111], v2, s[20:23], s32 offen offset:1024
    buffer_store_dwordx4 v[112:115], v2, s[20:23], s32 offen offset:2048
    buffer_store_dwordx4 v[116:119], v2, s[20:23], s32 offen offset:3072
    buffer_store_dwordx4 v[120:123], v2, s[20:23], s33 offen offset:0
    buffer_store_dwordx4 v[124:127], v2, s[20:23], s33 offen offset:1024
    buffer_store_dwordx4 v[128:131], v2, s[20:23], s33 offen offset:2048
L_hs_act_d:
    s_lshl_b32 s33, s49, 4
    s_add_u32 s33, s33, s28
    s_lshl_b32 s33, s33, 2
    s_add_u32 s33, s33, 29114368
    s_lshr_b32 s50, s40, 1
    s_mul_i32 s37, s44, 28672
    v_add_u32 v5, s37, v2
    s_waitcnt vmcnt(0)
    v_mov_b32 v3, 0
    v_mov_b32 v4, 1
    s_mov_b64 exec, 1
    s_cmp_eq_u32 s63, -1
    s_cbranch_scc1 L_hs_fc_f
    buffer_store_dword v4, v3, s[20:23], s33 offen sc1
    s_branch L_hs_fc_d
L_hs_fc_f:
    buffer_store_dword v4, v3, s[20:23], s33 offen
L_hs_fc_d:
    s_mov_b64 exec, -1
    s_barrier
    ds_read_b128 v[144:147], v5 offset:0
    ds_read_b128 v[148:151], v5 offset:1024
    ds_read_b128 v[152:155], v5 offset:2048
    ds_read_b128 v[156:159], v5 offset:3072
    ds_read_b128 v[160:163], v5 offset:4096
    ds_read_b128 v[164:167], v5 offset:5120
    ds_read_b128 v[168:171], v5 offset:6144
    ds_read_b128 v[172:175], v5 offset:7168
    s_waitcnt lgkmcnt(4)
    ds_read_b128 v[176:179], v5 offset:8192
    ds_read_b128 v[180:183], v5 offset:9216
    ds_read_b128 v[184:187], v5 offset:10240
    ds_read_b128 v[188:191], v5 offset:11264
    ds_read_b128 v[192:195], v5 offset:12288
    ds_read_b128 v[196:199], v5 offset:13312
    ds_read_b128 v[200:203], v5 offset:14336
    ds_read_b128 v[204:207], v5 offset:15360
    s_waitcnt lgkmcnt(4)
    ds_read_b128 v[208:211], v5 offset:16384
    ds_read_b128 v[212:215], v5 offset:17408
    ds_read_b128 v[216:219], v5 offset:18432
    ds_read_b128 v[220:223], v5 offset:19456
    ds_read_b128 v[224:227], v5 offset:20480
    ds_read_b128 v[228:231], v5 offset:21504
    ds_read_b128 v[232:235], v5 offset:22528
    ds_read_b128 v[236:239], v5 offset:23552
    s_waitcnt lgkmcnt(4)
    ds_read_b128 v[240:243], v5 offset:24576
    ds_read_b128 v[244:247], v5 offset:25600
    ds_read_b128 v[248:251], v5 offset:26624
    ds_read_b128 v[252:255], v5 offset:27648
    s_waitcnt lgkmcnt(0)
L_f_d1:
    s_setprio 0
    s_and_b32 s32, s40, 1
    s_lshl_b32 s33, s26, 1
    s_add_u32 s32, s32, s33
    s_lshl_b32 s32, s32, 2
    s_add_u32 s32, s32, s50
    s_mul_i32 s45, s32, 28672
    s_add_u32 s45, s45, 10485760
    s_lshl_b32 s46, s40, 12
    s_and_b32 s32, s50, 1
    s_xor_b32 s32, s32, 0
    s_lshl_b32 s33, s50, 1
    s_add_u32 s32, s32, s33
    s_lshl_b32 s32, s32, 12
    v_add_u32 v12, s32, v2
    s_and_b32 s32, s50, 1
    s_xor_b32 s32, s32, 1
    s_lshl_b32 s33, s50, 1
    s_add_u32 s32, s32, s33
    s_lshl_b32 s32, s32, 12
    v_add_u32 v13, s32, v2
    s_cmp_lg_u32 s40, 0
    s_cbranch_scc1 L_f_d2
    s_lshl_b32 s32, s26, 7
    s_add_u32 s32, s32, 29114368
    s_mov_b32 s36, 0
L_poll_fc:
    buffer_load_dword v9, v15, s[20:23], s32 offen sc1
    s_add_u32 s36, s36, 1
    s_waitcnt vmcnt(0)
    v_cmp_ne_u32 vcc, 0, v9
    s_cmp_gt_u32 s36, 0x40000
    s_cbranch_scc1 L_polld_fc
    s_and_b32 s37, vcc_lo, 0xffffffff
    s_cmp_lg_u32 s37, 0xffffffff
    s_cbranch_scc1 L_poll_fc
L_polld_fc:
L_f_d2:
    s_barrier
    s_add_u32 m0, s46, 0
    s_add_u32 s34, s45, 0
    buffer_load_dwordx4 v2, s[20:23], s34 offen offset:0 sc1 lds
    buffer_load_dwordx4 v2, s[20:23], s34 offen offset:1024 sc1 lds
    buffer_load_dwordx4 v2, s[20:23], s34 offen offset:2048 sc1 lds
    buffer_load_dwordx4 v2, s[20:23], s34 offen offset:3072 sc1 lds
    s_barrier
    s_add_u32 m0, s46, 32768
    s_add_u32 s34, s45, 4096
    buffer_load_dwordx4 v2, s[20:23], s34 offen offset:0 sc1 lds
    buffer_load_dwordx4 v2, s[20:23], s34 offen offset:1024 sc1 lds
    buffer_load_dwordx4 v2, s[20:23], s34 offen offset:2048 sc1 lds
    buffer_load_dwordx4 v2, s[20:23], s34 offen offset:3072 sc1 lds
    s_waitcnt vmcnt(4) lgkmcnt(0)
    s_barrier
    s_add_u32 m0, s46, 65536
    s_add_u32 s34, s45, 8192
    buffer_load_dwordx4 v2, s[20:23], s34 offen offset:0 sc1 lds
    ds_read_b128 v[32:35], v12 offset:0
    ds_read_b128 v[36:39], v13 offset:0
    ds_read_b128 v[40:43], v12 offset:1024
    ds_read_b128 v[44:47], v13 offset:1024
    ds_read_b128 v[48:51], v12 offset:2048
    ds_read_b128 v[52:55], v13 offset:2048
    ds_read_b128 v[56:59], v12 offset:3072
    ds_read_b128 v[60:63], v13 offset:3072
    s_waitcnt lgkmcnt(7)
    v_mfma_f32_32x32x16_bf16 v[96:111], v[144:147], v[32:35], 0
    buffer_load_dwordx4 v2, s[20:23], s34 offen offset:1024 sc1 lds
    s_waitcnt lgkmcnt(6)
    v_mfma_f32_32x32x16_bf16 v[112:127], v[144:147], v[36:39], 0
    buffer_load_dwordx4 v2, s[20:23], s34 offen offset:2048 sc1 lds
    s_waitcnt lgkmcnt(5)
    v_mfma_f32_32x32x16_bf16 v[96:111], v[148:151], v[40:43], v[96:111]
    buffer_load_dwordx4 v2, s[20:23], s34 offen offset:3072 sc1 lds
    s_waitcnt lgkmcnt(4)
    v_mfma_f32_32x32x16_bf16 v[112:127], v[148:151], v[44:47], v[112:127]
    s_waitcnt lgkmcnt(3)
    v_mfma_f32_32x32x16_bf16 v[96:111], v[152:155], v[48:51], v[96:111]
    s_waitcnt lgkmcnt(2)
    v_mfma_f32_32x32x16_bf16 v[112:127], v[152:155], v[52:55], v[112:127]
    s_waitcnt lgkmcnt(1)
    v_mfma_f32_32x32x16_bf16 v[96:111], v[156:159], v[56:59], v[96:111]
    s_waitcnt lgkmcnt(0)
    v_mfma_f32_32x32x16_bf16 v[112:127], v[156:159], v[60:63], v[112:127]
    s_waitcnt vmcnt(4) lgkmcnt(0)
    s_barrier
    s_add_u32 m0, s46, 98304
    s_add_u32 s34, s45, 12288
    buffer_load_dwordx4 v2, s[20:23], s34 offen offset:0 sc1 lds
    ds_read_b128 v[64:67], v12 offset:32768
    ds_read_b128 v[68:71], v13 offset:32768
    ds_read_b128 v[72:75], v12 offset:33792
    ds_read_b128 v[76:79], v13 offset:33792
    ds_read_b128 v[80:83], v12 offset:34816
    ds_read_b128 v[84:87], v13 offset:34816
    ds_read_b128 v[88:91], v12 offset:35840
    ds_read_b128 v[92:95], v13 offset:35840
    s_waitcnt lgkmcnt(7)
    v_mfma_f32_32x32x16_bf16 v[96:111], v[160:163], v[64:67], v[96:111]
    buffer_load_dwordx4 v2, s[20:23], s34 offen offset:1024 sc1 lds
    s_waitcnt lgkmcnt(6)
    v_mfma_f32_32x32x16_bf16 v[112:127], v[160:163], v[68:71], v[112:127]
    buffer_load_dwordx4 v2, s[20:23], s34 offen offset:2048 sc1 lds
    s_waitcnt lgkmcnt(5)
    v_mfma_f32_32x32x16_bf16 v[96:111], v[164:167], v[72:75], v[96:111]
    buffer_load_dwordx4 v2, s[20:23], s34 offen offset:3072 sc1 lds
    s_waitcnt lgkmcnt(4)
    v_mfma_f32_32x32x16_bf16 v[112:127], v[164:167], v[76:79], v[112:127]
    s_waitcnt lgkmcnt(3)
    v_mfma_f32_32x32x16_bf16 v[96:111], v[168:171], v[80:83], v[96:111]
    s_waitcnt lgkmcnt(2)
    v_mfma_f32_32x32x16_bf16 v[112:127], v[168:171], v[84:87], v[112:127]
    s_waitcnt lgkmcnt(1)
    v_mfma_f32_32x32x16_bf16 v[96:111], v[172:175], v[88:91], v[96:111]
    s_waitcnt lgkmcnt(0)
    v_mfma_f32_32x32x16_bf16 v[112:127], v[172:175], v[92:95], v[112:127]
    v_add_u32 v12, 65536, v12
    v_add_u32 v13, 65536, v13
    s_waitcnt vmcnt(4) lgkmcnt(0)
    s_barrier
    s_add_u32 m0, s46, 131072
    s_add_u32 s34, s45, 16384
    buffer_load_dwordx4 v2, s[20:23], s34 offen offset:0 sc1 lds
    ds_read_b128 v[32:35], v12 offset:0
    ds_read_b128 v[36:39], v13 offset:0
    ds_read_b128 v[40:43], v12 offset:1024
    ds_read_b128 v[44:47], v13 offset:1024
    ds_read_b128 v[48:51], v12 offset:2048
    ds_read_b128 v[52:55], v13 offset:2048
    ds_read_b128 v[56:59], v12 offset:3072
    ds_read_b128 v[60:63], v13 offset:3072
    s_waitcnt lgkmcnt(7)
    v_mfma_f32_32x32x16_bf16 v[96:111], v[176:179], v[32:35], v[96:111]
    buffer_load_dwordx4 v2, s[20:23], s34 offen offset:1024 sc1 lds
    s_waitcnt lgkmcnt(6)
    v_mfma_f32_32x32x16_bf16 v[112:127], v[176:179], v[36:39], v[112:127]
    buffer_load_dwordx4 v2, s[20:23], s34 offen offset:2048 sc1 lds
    s_waitcnt lgkmcnt(5)
    v_mfma_f32_32x32x16_bf16 v[96:111], v[180:183], v[40:43], v[96:111]
    buffer_load_dwordx4 v2, s[20:23], s34 offen offset:3072 sc1 lds
    s_waitcnt lgkmcnt(4)
    v_mfma_f32_32x32x16_bf16 v[112:127], v[180:183], v[44:47], v[112:127]
    s_waitcnt lgkmcnt(3)
    v_mfma_f32_32x32x16_bf16 v[96:111], v[184:187], v[48:51], v[96:111]
    s_waitcnt lgkmcnt(2)
    v_mfma_f32_32x32x16_bf16 v[112:127], v[184:187], v[52:55], v[112:127]
    s_waitcnt lgkmcnt(1)
    v_mfma_f32_32x32x16_bf16 v[96:111], v[188:191], v[56:59], v[96:111]
    s_waitcnt lgkmcnt(0)
    v_mfma_f32_32x32x16_bf16 v[112:127], v[188:191], v[60:63], v[112:127]
    s_waitcnt vmcnt(4) lgkmcnt(0)
    s_barrier
    s_add_u32 m0, s46, 0
    s_add_u32 s34, s45, 20480
    buffer_load_dwordx4 v2, s[20:23], s34 offen offset:0 sc1 lds
    ds_read_b128 v[64:67], v12 offset:32768
    ds_read_b128 v[68:71], v13 offset:32768
    ds_read_b128 v[72:75], v12 offset:33792
    ds_read_b128 v[76:79], v13 offset:33792
    ds_read_b128 v[80:83], v12 offset:34816
    ds_read_b128 v[84:87], v13 offset:34816
    ds_read_b128 v[88:91], v12 offset:35840
    ds_read_b128 v[92:95], v13 offset:35840
    s_waitcnt lgkmcnt(7)
    v_mfma_f32_32x32x16_bf16 v[96:111], v[192:195], v[64:67], v[96:111]
    buffer_load_dwordx4 v2, s[20:23], s34 offen offset:1024 sc1 lds
    s_waitcnt lgkmcnt(6)
    v_mfma_f32_32x32x16_bf16 v[112:127], v[192:195], v[68:71], v[112:127]
    buffer_load_dwordx4 v2, s[20:23], s34 offen offset:2048 sc1 lds
    s_waitcnt lgkmcnt(5)
    v_mfma_f32_32x32x16_bf16 v[96:111], v[196:199], v[72:75], v[96:111]
    buffer_load_dwordx4 v2, s[20:23], s34 offen offset:3072 sc1 lds
    s_waitcnt lgkmcnt(4)
    v_mfma_f32_32x32x16_bf16 v[112:127], v[196:199], v[76:79], v[112:127]
    s_waitcnt lgkmcnt(3)
    v_mfma_f32_32x32x16_bf16 v[96:111], v[200:203], v[80:83], v[96:111]
    s_waitcnt lgkmcnt(2)
    v_mfma_f32_32x32x16_bf16 v[112:127], v[200:203], v[84:87], v[112:127]
    s_waitcnt lgkmcnt(1)
    v_mfma_f32_32x32x16_bf16 v[96:111], v[204:207], v[88:91], v[96:111]
    s_waitcnt lgkmcnt(0)
    v_mfma_f32_32x32x16_bf16 v[112:127], v[204:207], v[92:95], v[112:127]
    v_add_u32 v12, 65536, v12
    v_add_u32 v13, 65536, v13
    s_waitcnt vmcnt(4) lgkmcnt(0)
    s_barrier
    s_add_u32 m0, s46, 32768
    s_add_u32 s34, s45, 24576
    buffer_load_dwordx4 v2, s[20:23], s34 offen offset:0 sc1 lds
    ds_read_b128 v[32:35], v12 offset:0
    ds_read_b128 v[36:39], v13 offset:0
    ds_read_b128 v[40:43], v12 offset:1024
    ds_read_b128 v[44:47], v13 offset:1024
    ds_read_b128 v[48:51], v12 offset:2048
    ds_read_b128 v[52:55], v13 offset:2048
    ds_read_b128 v[56:59], v12 offset:3072
    ds_read_b128 v[60:63], v13 offset:3072
    s_waitcnt lgkmcnt(7)
    v_mfma_f32_32x32x16_bf16 v[96:111], v[208:211], v[32:35], v[96:111]
    buffer_load_dwordx4 v2, s[20:23], s34 offen offset:1024 sc1 lds
    s_waitcnt lgkmcnt(6)
    v_mfma_f32_32x32x16_bf16 v[112:127], v[208:211], v[36:39], v[112:127]
    buffer_load_dwordx4 v2, s[20:23], s34 offen offset:2048 sc1 lds
    s_waitcnt lgkmcnt(5)
    v_mfma_f32_32x32x16_bf16 v[96:111], v[212:215], v[40:43], v[96:111]
    buffer_load_dwordx4 v2, s[20:23], s34 offen offset:3072 sc1 lds
    s_waitcnt lgkmcnt(4)
    v_mfma_f32_32x32x16_bf16 v[112:127], v[212:215], v[44:47], v[112:127]
    s_waitcnt lgkmcnt(3)
    v_mfma_f32_32x32x16_bf16 v[96:111], v[216:219], v[48:51], v[96:111]
    s_waitcnt lgkmcnt(2)
    v_mfma_f32_32x32x16_bf16 v[112:127], v[216:219], v[52:55], v[112:127]
    s_waitcnt lgkmcnt(1)
    v_mfma_f32_32x32x16_bf16 v[96:111], v[220:223], v[56:59], v[96:111]
    s_waitcnt lgkmcnt(0)
    v_mfma_f32_32x32x16_bf16 v[112:127], v[220:223], v[60:63], v[112:127]
    v_subrev_u32 v12, 131072, v12
    v_subrev_u32 v13, 131072, v13
    s_waitcnt vmcnt(4) lgkmcnt(0)
    s_barrier
    ds_read_b128 v[64:67], v12 offset:0
    ds_read_b128 v[68:71], v13 offset:0
    ds_read_b128 v[72:75], v12 offset:1024
    ds_read_b128 v[76:79], v13 offset:1024
    ds_read_b128 v[80:83], v12 offset:2048
    ds_read_b128 v[84:87], v13 offset:2048
    ds_read_b128 v[88:91], v12 offset:3072
    ds_read_b128 v[92:95], v13 offset:3072
    s_waitcnt lgkmcnt(7)
    v_mfma_f32_32x32x16_bf16 v[96:111], v[224:227], v[64:67], v[96:111]
    s_waitcnt lgkmcnt(6)
    v_mfma_f32_32x32x16_bf16 v[112:127], v[224:227], v[68:71], v[112:127]
    s_waitcnt lgkmcnt(5)
    v_mfma_f32_32x32x16_bf16 v[96:111], v[228:231], v[72:75], v[96:111]
    s_waitcnt lgkmcnt(4)
    v_mfma_f32_32x32x16_bf16 v[112:127], v[228:231], v[76:79], v[112:127]
    s_waitcnt lgkmcnt(3)
    v_mfma_f32_32x32x16_bf16 v[96:111], v[232:235], v[80:83], v[96:111]
    s_waitcnt lgkmcnt(2)
    v_mfma_f32_32x32x16_bf16 v[112:127], v[232:235], v[84:87], v[112:127]
    s_waitcnt lgkmcnt(1)
    v_mfma_f32_32x32x16_bf16 v[96:111], v[236:239], v[88:91], v[96:111]
    s_waitcnt lgkmcnt(0)
    v_mfma_f32_32x32x16_bf16 v[112:127], v[236:239], v[92:95], v[112:127]
    s_waitcnt vmcnt(0) lgkmcnt(0)
    s_barrier
    s_lshl_b32 s32, s19, 3
    s_add_u32 s32, s32, s40
    s_cmp_lg_u32 s32, 7
    s_cbranch_scc1 L_f_nowb3
    buffer_wbl2 sc1
L_f_nowb3:
    ds_read_b128 v[32:35], v12 offset:32768
    ds_read_b128 v[36:39], v13 offset:32768
    ds_read_b128 v[40:43], v12 offset:33792
    ds_read_b128 v[44:47], v13 offset:33792
    ds_read_b128 v[48:51], v12 offset:34816
    ds_read_b128 v[52:55], v13 offset:34816
    ds_read_b128 v[56:59], v12 offset:35840
    ds_read_b128 v[60:63], v13 offset:35840
    s_waitcnt lgkmcnt(7)
    v_mfma_f32_32x32x16_bf16 v[96:111], v[240:243], v[32:35], v[96:111]
    s_waitcnt lgkmcnt(6)
    v_mfma_f32_32x32x16_bf16 v[112:127], v[240:243], v[36:39], v[112:127]
    s_waitcnt lgkmcnt(5)
    v_mfma_f32_32x32x16_bf16 v[96:111], v[244:247], v[40:43], v[96:111]
    s_waitcnt lgkmcnt(4)
    v_mfma_f32_32x32x16_bf16 v[112:127], v[244:247], v[44:47], v[112:127]
    s_waitcnt lgkmcnt(3)
    v_mfma_f32_32x32x16_bf16 v[96:111], v[248:251], v[48:51], v[96:111]
    s_waitcnt lgkmcnt(2)
    v_mfma_f32_32x32x16_bf16 v[112:127], v[248:251], v[52:55], v[112:127]
    s_waitcnt lgkmcnt(1)
    v_mfma_f32_32x32x16_bf16 v[96:111], v[252:255], v[56:59], v[96:111]
    s_waitcnt lgkmcnt(0)
    v_mfma_f32_32x32x16_bf16 v[112:127], v[252:255], v[60:63], v[112:127]
    s_xor_b32 s32, s40, 2
    s_mul_i32 s32, s32, 6144
    s_add_u32 s32, s32, 65536
    v_add_u32 v4, s32, v2
    s_xor_b32 s32, s40, 4
    s_mul_i32 s32, s32, 6144
    s_add_u32 s32, s32, 67584
    v_add_u32 v5, s32, v2
    s_xor_b32 s32, s40, 6
    s_mul_i32 s32, s32, 6144
    s_add_u32 s32, s32, 69632
    v_add_u32 v6, s32, v2
    s_mul_i32 s32, s40, 6144
    s_add_u32 s32, s32, 65536
    v_add_u32 v3, s32, v2
    ds_write_b128 v5, v[104:107] offset:0
    ds_write_b128 v5, v[108:111] offset:1024
    ds_write_b128 v4, v[112:115] offset:0
    ds_write_b128 v4, v[116:119] offset:1024
    ds_write_b128 v6, v[120:123] offset:0
    ds_write_b128 v6, v[124:127] offset:1024
    v_lshlrev_b32 v32, 16, v16
    v_and_b32 v33, s43, v16
    v_lshlrev_b32 v34, 16, v17
    v_and_b32 v35, s43, v17
    v_lshlrev_b32 v36, 16, v18
    v_and_b32 v37, s43, v18
    v_lshlrev_b32 v38, 16, v19
    v_and_b32 v39, s43, v19
    v_add_f32 v96, v96, v32
    v_add_f32 v97, v97, v33
    v_add_f32 v98, v98, v34
    v_add_f32 v99, v99, v35
    v_add_f32 v100, v100, v36
    v_add_f32 v101, v101, v37
    v_add_f32 v102, v102, v38
    v_add_f32 v103, v103, v39
    s_mov_b32 s12, s16
    s_mov_b32 s13, s17
    s_mov_b32 s14, 0x200000
    s_mov_b32 s15, 0x00020000
    v_and_b32 v7, 31, v1
    v_lshlrev_b32 v7, 10, v7
    v_lshrrev_b32 v8, 5, v1
    v_lshl_add_u32 v7, v8, 3, v7
    s_lshl_b32 s32, s29, 15
    s_lshl_b32 s33, s30, 6
    s_add_u32 s32, s32, s33
    s_lshl_b32 s33, s31, 5
    s_add_u32 s32, s32, s33
    s_waitcnt lgkmcnt(0)
    s_barrier
    ds_read_b128 v[48:51], v3 offset:0
    ds_read_b128 v[52:55], v3 offset:1024
    ds_read_b128 v[56:59], v3 offset:2048
    ds_read_b128 v[60:63], v3 offset:3072
    ds_read_b128 v[64:67], v3 offset:4096
    ds_read_b128 v[68:71], v3 offset:5120
    s_waitcnt lgkmcnt(4)
    v_add_f32 v96, v96, v48
    v_add_f32 v97, v97, v49
    v_add_f32 v98, v98, v50
    v_add_f32 v99, v99, v51
    v_add_f32 v100, v100, v52
    v_add_f32 v101, v101, v53
    v_add_f32 v102, v102, v54
    v_add_f32 v103, v103, v55
    s_waitcnt lgkmcnt(2)
    v_add_f32 v96, v96, v56
    v_add_f32 v97, v97, v57
    v_add_f32 v98, v98, v58
    v_add_f32 v99, v99, v59
    v_add_f32 v100, v100, v60
    v_add_f32 v101, v101, v61
    v_add_f32 v102, v102, v62
    v_add_f32 v103, v103, v63
    s_waitcnt lgkmcnt(0)
    v_add_f32 v96, v96, v64
    v_add_f32 v97, v97, v65
    v_add_f32 v98, v98, v66
    v_add_f32 v99, v99, v67
    v_add_f32 v100, v100, v68
    v_add_f32 v101, v101, v69
    v_add_f32 v102, v102, v70
    v_add_f32 v103, v103, v71
    v_cvt_pk_bf16_f32 v32, v96, v97
    v_cvt_pk_bf16_f32 v33, v98, v99
    v_cvt_pk_bf16_f32 v34, v100, v101
    v_cvt_pk_bf16_f32 v35, v102, v103
    buffer_store_dwordx2 v[32:33], v7, s[12:15], s32 offen offset:0
    buffer_store_dwordx2 v[34:35], v7, s[12:15], s32 offen offset:16
L_f_end:
    s_endpgm
L_f_event:
    s_cmp_eq_u32 s47, 7
    s_cbranch_scc1 L_f_sync
    s_cmp_eq_u32 s47, 6
    s_cbranch_scc1 L_f_ev6
    s_cmp_eq_u32 s47, 2
    s_cbranch_scc1 L_f_ev1
    s_cmp_eq_u32 s47, 3
    s_cbranch_scc1 L_f_ev2
    s_cmp_eq_u32 s47, 4
    s_cbranch_scc1 L_f_ev3
    s_mov_b32 s48, 4
    s_cmp_eq_u32 s55, 0
    s_cbranch_scc1 L_f_ev5b
    s_lshl_b32 s32, s51, 2
    s_add_u32 s32, s32, 29118464
    s_waitcnt vmcnt(0)
    v_mov_b32 v3, 0
    v_mov_b32 v4, 1
    s_mov_b64 exec, 1
    buffer_store_dword v4, v3, s[20:23], s32 offen sc1
    s_mov_b64 exec, -1
L_f_ev5b:
    buffer_load_dword v230, v229, s[96:99], 0 offen sc1
    s_branch L_f_syncret
L_f_ev3:
    s_mov_b32 s48, 3
    s_mov_b32 s36, 0
L_f_dbchk:
    s_waitcnt vmcnt(0)
    v_subrev_u32 v231, 0x01010101, v230
    v_not_b32 v232, v230
    v_and_b32 v231, v231, v232
    v_and_b32 v231, 0x80808080, v231
    v_cmp_eq_u32 vcc, 0, v231
    s_add_u32 s36, s36, 1
    s_cmp_gt_u32 s36, 0x40000
    s_cbranch_scc1 L_f_dbok
    s_and_b32 s37, vcc_lo, vcc_hi
    s_cmp_eq_u32 s37, -1
    s_cbranch_scc1 L_f_dbok
    buffer_load_dword v230, v229, s[96:99], 0 offen sc1
    s_branch L_f_dbchk
L_f_dbok:
    s_lshr_b32 s24, s2, 5
    s_bfe_u32 s25, s2, 0x20003
    s_and_b32 s26, s2, 7
    s_lshl_b32 s26, s26, 2
    s_add_u32 s26, s26, s25
    s_lshr_b32 s27, s26, 1
    s_and_b32 s32, s25, 1
    s_lshl_b32 s28, s24, 1
    s_add_u32 s28, s28, s32
    s_bfe_u32 s32, s40, 0x10001
    s_lshl_b32 s29, s26, 1
    s_add_u32 s29, s29, s32
    s_and_b32 s32, s40, 1
    s_lshl_b32 s30, s24, 1
    s_add_u32 s30, s30, s32
    s_lshr_b32 s31, s40, 2
    s_lshl_b32 s32, s29, 4
    s_add_u32 s32, s32, s30
    s_lshl_b32 s33, s32, 9
    s_add_u32 s33, s33, 26214400
    s_lshl_b32 s32, s32, 1
    s_add_u32 s32, s32, s31
    s_lshl_b32 s32, s32, 10
    s_add_u32 s32, s32, 8388608
    buffer_load_dwordx4 v[236:239], v2, s[20:23], s32 offen sc1
    buffer_load_dwordx2 v[240:241], v234, s[20:23], s33 offen sc1
    s_and_b32 s32, s40, 3
    s_lshl_b32 s33, s27, 2
    s_add_u32 s32, s32, s33
    s_mul_i32 s32, s32, 112
    s_mul_i32 s33, s28, 7
    s_add_u32 s32, s32, s33
    s_mul_i32 s33, s31, 3
    s_add_u32 s32, s32, s33
    s_lshl_b32 s32, s32, 10
    s_add_u32 s32, s32, 10485760
    buffer_load_dwordx4 v[236:239], v2, s[20:23], s32 offen offset:0 sc1
    buffer_load_dwordx4 v[244:247], v2, s[20:23], s32 offen offset:1024 sc1
    buffer_load_dwordx4 v[248:251], v2, s[20:23], s32 offen offset:2048 sc1
    buffer_load_dwordx4 v[252:255], v2, s[20:23], s32 offen offset:3072 sc1
    s_mul_i32 s32, s28, 7
    s_lshr_b32 s32, s32, 1
    s_lshl_b32 s32, s32, 5
    s_mul_i32 s33, s30, 56
    s_add_u32 s33, s33, 1920
    s_lshl_b32 s34, s30, 1
    s_add_u32 s34, s34, s31
    s_lshl_b32 s34, s34, 3
    s_add_u32 s34, s34, 1608
    v_mov_b32 v3, s32
    v_mov_b32 v4, s33
    v_cmp_le_u32 vcc, 32, v1
    v_mov_b32 v5, s34
    s_nop 0
    v_cndmask_b32 v3, v3, v4, vcc
    v_cmp_le_u32 vcc, 46, v1
    s_mov_b32 s32, 29118464
    s_nop 0
    v_cndmask_b32 v3, v3, v5, vcc
    v_add_u32 v233, v3, v229
    buffer_load_dword v230, v233, s[20:23], s32 offen sc1
    s_branch L_f_syncret
L_f_ev2:
    s_mov_b32 s48, 2
    s_mov_b32 s36, 0
    s_mov_b32 s32, 29118464
L_f_fpchk:
    s_waitcnt vmcnt(0)
    v_cmp_ne_u32 vcc, 0, v230
    s_add_u32 s36, s36, 1
    s_cmp_gt_u32 s36, 0x40000
    s_cbranch_scc1 L_f_fpok
    s_or_b32 s37, vcc_hi, 0xffff0000
    s_and_b32 s37, s37, vcc_lo
    s_cmp_eq_u32 s37, -1
    s_cbranch_scc1 L_f_fpok
    buffer_load_dword v230, v233, s[20:23], s32 offen sc1
    s_branch L_f_fpchk
L_f_fpok:
    s_lshl_b32 s32, s30, 1
    s_add_u32 s32, s32, s31
    s_lshl_b32 s32, s32, 14
    s_add_u32 s32, s32, 17825792
    buffer_load_dwordx4 v[160:163], v228, s[20:23], s32 offen offset:0 sc1
    buffer_load_dwordx4 v[164:167], v228, s[20:23], s32 offen offset:1024 sc1
    buffer_load_dwordx4 v[168:171], v228, s[20:23], s32 offen offset:2048 sc1
    buffer_load_dwordx4 v[172:175], v228, s[20:23], s32 offen offset:3072 sc1
    s_add_u32 s32, s32, 4096
    buffer_load_dwordx4 v[176:179], v228, s[20:23], s32 offen offset:0 sc1
    buffer_load_dwordx4 v[180:183], v228, s[20:23], s32 offen offset:1024 sc1
    buffer_load_dwordx4 v[184:187], v228, s[20:23], s32 offen offset:2048 sc1
    buffer_load_dwordx4 v[188:191], v228, s[20:23], s32 offen offset:3072 sc1
    s_mov_b32 s35, s32
    s_branch L_f_syncret
L_f_ev1:
    s_mov_b32 s48, 0
    s_mov_b32 s32, s35
    s_add_u32 s32, s32, 4096
    buffer_load_dwordx4 v[192:195], v228, s[20:23], s32 offen offset:0 sc1
    buffer_load_dwordx4 v[196:199], v228, s[20:23], s32 offen offset:1024 sc1
    buffer_load_dwordx4 v[200:203], v228, s[20:23], s32 offen offset:2048 sc1
    buffer_load_dwordx4 v[204:207], v228, s[20:23], s32 offen offset:3072 sc1
    s_add_u32 s32, s32, 4096
    buffer_load_dwordx4 v[208:211], v228, s[20:23], s32 offen offset:0 sc1
    buffer_load_dwordx4 v[212:215], v228, s[20:23], s32 offen offset:1024 sc1
    buffer_load_dwordx4 v[216:219], v228, s[20:23], s32 offen offset:2048 sc1
    buffer_load_dwordx4 v[220:223], v228, s[20:23], s32 offen offset:3072 sc1
    s_mov_b32 s12, s10
    s_mov_b32 s13, s11
    s_mov_b32 s14, 0x200000
    s_mov_b32 s15, 0x00020000
    v_and_b32 v3, 31, v1
    v_lshlrev_b32 v3, 10, v3
    v_lshrrev_b32 v4, 5, v1
    v_lshl_add_u32 v3, v4, 3, v3
    s_lshl_b32 s32, s29, 15
    s_lshl_b32 s33, s30, 6
    s_add_u32 s32, s32, s33
    s_lshl_b32 s33, s31, 5
    s_add_u32 s32, s32, s33
    buffer_load_dwordx2 v[224:225], v3, s[12:15], s32 offen offset:0
    buffer_load_dwordx2 v[226:227], v3, s[12:15], s32 offen offset:16
    s_branch L_f_syncret
L_f_sync:
    s_mov_b32 s48, 6
    s_cmp_eq_u32 s55, 0
    s_cbranch_scc1 L_f_sy0
    s_waitcnt vmcnt(8)
    s_barrier
    s_branch L_f_syncret
L_f_sy0:
    s_waitcnt vmcnt(0)
    s_barrier
    s_branch L_f_syncret
L_f_ev6:
    s_mov_b32 s48, 5
    s_cmp_eq_u32 s55, 0
    s_cbranch_scc1 L_f_syncret
    s_waitcnt vmcnt(0)
    v_bfe_u32 v3, v1, 2, 2
    v_lshrrev_b32 v4, 5, v1
    v_lshl_add_u32 v3, v4, 2, v3
    v_lshlrev_b32 v3, 6, v3
    v_and_b32 v4, 3, v1
    v_lshl_add_u32 v3, v4, 3, v3
    v_add_u32 v3, s52, v3
    v_bfe_u32 v4, v1, 4, 1
    s_cmp_eq_u32 s55, 2
    s_cbranch_scc1 L_f_pk2
    v_lshl_add_u32 v113, v4, 10, v3
    ds_read_b64_tr_b16 v[128:129], v113 offset:0
    ds_read_b64_tr_b16 v[130:131], v113 offset:512
    ds_read_b64_tr_b16 v[132:133], v113 offset:32
    ds_read_b64_tr_b16 v[134:135], v113 offset:544
    ds_read_b64_tr_b16 v[136:137], v113 offset:2048
    ds_read_b64_tr_b16 v[138:139], v113 offset:2560
    ds_read_b64_tr_b16 v[140:141], v113 offset:2080
    ds_read_b64_tr_b16 v[142:143], v113 offset:2592
    ds_read_b64_tr_b16 v[144:145], v113 offset:4096
    ds_read_b64_tr_b16 v[146:147], v113 offset:4608
    ds_read_b64_tr_b16 v[148:149], v113 offset:4128
    ds_read_b64_tr_b16 v[150:151], v113 offset:4640
    ds_read_b64_tr_b16 v[152:153], v113 offset:6144
    ds_read_b64_tr_b16 v[154:155], v113 offset:6656
    ds_read_b64_tr_b16 v[156:157], v113 offset:6176
    ds_read_b64_tr_b16 v[158:159], v113 offset:6688
    v_lshrrev_b32 v5, 2, v1
    v_lshrrev_b32 v116, 4, v1
    v_xor_b32 v5, v5, v116
    v_and_b32 v5, 1, v5
    v_add_u32 v5, -1, v5
    v_and_b32 v116, 0x3f803f80, v5
    v_mov_b32 v117, v116
    v_mov_b32 v118, v116
    v_mov_b32 v119, v116
    v_and_b32 v3, 31, v1
    v_lshlrev_b32 v3, 4, v3
    s_waitcnt lgkmcnt(0)
    v_mfma_f32_16x16x32_bf16 v[120:123], v[116:119], v[128:131], 0
    buffer_store_dwordx4 v[128:131], v2, s[20:23], s53 offen sc1
    v_mfma_f32_16x16x32_bf16 v[124:127], v[116:119], v[132:135], 0
    buffer_store_dwordx4 v[132:135], v2, s[20:23], s54 offen sc1
    s_add_u32 s53, s53, 7168
    s_add_u32 s54, s54, 7168
    v_mfma_f32_16x16x32_bf16 v[120:123], v[116:119], v[136:139], v[120:123]
    buffer_store_dwordx4 v[136:139], v2, s[20:23], s53 offen sc1
    v_mfma_f32_16x16x32_bf16 v[124:127], v[116:119], v[140:143], v[124:127]
    buffer_store_dwordx4 v[140:143], v2, s[20:23], s54 offen sc1
    s_add_u32 s53, s53, 7168
    s_add_u32 s54, s54, 7168
    v_mfma_f32_16x16x32_bf16 v[120:123], v[116:119], v[144:147], v[120:123]
    buffer_store_dwordx4 v[144:147], v2, s[20:23], s53 offen sc1
    v_mfma_f32_16x16x32_bf16 v[124:127], v[116:119], v[148:151], v[124:127]
    buffer_store_dwordx4 v[148:151], v2, s[20:23], s54 offen sc1
    s_add_u32 s53, s53, 7168
    s_add_u32 s54, s54, 7168
    v_mfma_f32_16x16x32_bf16 v[120:123], v[116:119], v[152:155], v[120:123]
    buffer_store_dwordx4 v[152:155], v2, s[20:23], s53 offen sc1
    v_mfma_f32_16x16x32_bf16 v[124:127], v[116:119], v[156:159], v[124:127]
    buffer_store_dwordx4 v[156:159], v2, s[20:23], s54 offen sc1
    s_add_u32 s53, s53, 7168
    s_add_u32 s54, s54, 7168
    s_nop 7
    buffer_store_dword v120, v3, s[20:23], s58 offen sc1
    buffer_store_dword v124, v3, s[20:23], s58 offen offset:1024 sc1
    s_branch L_f_syncret
L_f_pk2:
    v_lshl_add_u32 v113, v4, 5, v3
    s_add_u32 s54, s53, 4096
    ds_read_b64_tr_b16 v[128:129], v113 offset:0
    ds_read_b64_tr_b16 v[130:131], v113 offset:512
    ds_read_b64_tr_b16 v[132:133], v113 offset:1024
    ds_read_b64_tr_b16 v[134:135], v113 offset:1536
    ds_read_b64_tr_b16 v[136:137], v113 offset:2048
    ds_read_b64_tr_b16 v[138:139], v113 offset:2560
    ds_read_b64_tr_b16 v[140:141], v113 offset:3072
    ds_read_b64_tr_b16 v[142:143], v113 offset:3584
    ds_read_b64_tr_b16 v[144:145], v113 offset:4096
    ds_read_b64_tr_b16 v[146:147], v113 offset:4608
    ds_read_b64_tr_b16 v[148:149], v113 offset:5120
    ds_read_b64_tr_b16 v[150:151], v113 offset:5632
    ds_read_b64_tr_b16 v[152:153], v113 offset:6144
    ds_read_b64_tr_b16 v[154:155], v113 offset:6656
    ds_read_b64_tr_b16 v[156:157], v113 offset:7168
    ds_read_b64_tr_b16 v[158:159], v113 offset:7680
    s_waitcnt lgkmcnt(0)
    buffer_store_dwordx4 v[128:131], v2, s[20:23], s53 offen offset:0 sc1
    buffer_store_dwordx4 v[132:135], v2, s[20:23], s53 offen offset:1024 sc1
    buffer_store_dwordx4 v[136:139], v2, s[20:23], s53 offen offset:2048 sc1
    buffer_store_dwordx4 v[140:143], v2, s[20:23], s53 offen offset:3072 sc1
    buffer_store_dwordx4 v[144:147], v2, s[20:23], s54 offen offset:0 sc1
    buffer_store_dwordx4 v[148:151], v2, s[20:23], s54 offen offset:1024 sc1
    buffer_store_dwordx4 v[152:155], v2, s[20:23], s54 offen offset:2048 sc1
    buffer_store_dwordx4 v[156:159], v2, s[20:23], s54 offen offset:3072 sc1
    s_branch L_f_syncret
.section .rodata,"a"
.p2align 6
.amdhsa_kernel sequential_preLN__softmax_full_mha__geglu_ffn__prompt_kernel
  .amdhsa_next_free_vgpr 256
  .amdhsa_next_free_sgpr 102
  .amdhsa_accum_offset 256
  .amdhsa_group_segment_fixed_size 0
  .amdhsa_kernarg_size 80
  .amdhsa_user_sgpr_count 2
  .amdhsa_user_sgpr_kernarg_segment_ptr 1
  .amdhsa_system_sgpr_workgroup_id_x 1
.end_amdhsa_kernel
```
